```python
import torch

def _softmax(x, axis=-1):
    return torch.softmax(x, dim=axis)
def _gelu(x):
    return torch.nn.functional.gelu(x, approximate="tanh")
def _silu(x):
    return torch.nn.functional.silu(x)
def _sigmoid(x):
    return torch.sigmoid(x)
def _layernorm(x, axis=-1, eps=1e-5):
    m = x.mean(dim=axis, keepdim=True)
    v = x.var(dim=axis, keepdim=True, unbiased=False)
    return (x - m) / torch.sqrt(v + eps)
def _scatter_add(tgt, idx, src, axis=0):
    return tgt.clone().index_add_(axis, idx, src)
def _segment_sum(src, seg, n):
    out = torch.zeros((n,) + src.shape[1:], dtype=src.dtype)
    return out.index_add_(0, seg, src)
def _pad(x, pw):
    flat = tuple(v for pair in reversed(pw) for v in pair)
    return torch.nn.functional.pad(x, flat)

kernel_name = 'standalone__mha_block_cached__near_ridge'

def setup_inputs():

    _w = (lambda a: (lambda t: t.to(torch.bfloat16) if t.is_floating_point() else t)(torch.as_tensor(a)))
    B, Sq, D = 8, 192, 640
    H, Sk, Dh = 32, 512, 128
    return {
        "x": _w((lambda *s: torch.randn(*s, dtype=torch.bfloat16) * 0.8)(B, Sq, D)),
        "k_cache": _w((lambda *s: torch.randn(*s, dtype=torch.bfloat16) * 0.8)(B, H, Sk, Dh)),
        "v_cache": _w((lambda *s: torch.randn(*s, dtype=torch.bfloat16) * 0.05)(B, H, Sk, Dh)),
        "wq": _w((lambda *s: torch.randn(*s, dtype=torch.bfloat16) * 0.8)(D, H * Dh) * (D ** -0.5)),
        "wo": _w((lambda *s: torch.randn(*s, dtype=torch.bfloat16) * 0.05)(H * Dh, D) * ((H * Dh) ** -0.5)),
    }

def reference(x, k_cache, v_cache, wq, wo):
    B, Sq, D = x.shape
    H, Dh = 32, 128
    q = (lambda x, *d: x.permute(*d))((x @ wq).reshape(B, Sq, H, Dh), 0, 2, 1, 3)
    scores = torch.einsum("bhqd,bhkd->bhqk", q, k_cache) * (Dh ** -0.5)
    p = _softmax(scores, axis=-1)
    o = torch.einsum("bhqk,bhkd->bhqd", p, v_cache)
    return (lambda x, *d: x.permute(*d))(o, 0, 2, 1, 3).reshape(B, Sq, H * Dh) @ wo
```

```asm
; @launch grid=(256,1,1) block=(768,1,1) lds=163840
.amdgcn_target "amdgcn-amd-amdhsa--gfx950"
.text
.globl standalone__mha_block_cached__near_ridge_kernel
.p2align 8
.type standalone__mha_block_cached__near_ridge_kernel,@function
standalone__mha_block_cached__near_ridge_kernel:
  s_cmp_ge_u32 s2, 256
  s_cbranch_scc1 K_end
  s_load_dwordx16 s[16:31], s[0:1], 0
  v_lshrrev_b32 v1, 6, v0
  v_and_b32 v144, 63, v0
  v_lshrrev_b32 v145, 4, v144
  v_and_b32 v146, 15, v144
  v_and_b32 v147, 31, v144
  v_lshrrev_b32 v148, 5, v144
  v_lshrrev_b32 v149, 2, v146
  v_and_b32 v150, 3, v144
  v_and_b32 v151, 1, v150
  v_lshlrev_b32 v151, 1, v151
  v_lshrrev_b32 v153, 1, v150
  v_or_b32 v151, v151, v153
  v_lshlrev_b32 v151, 3, v151
  v_and_b32 v153, 1, v145
  v_lshlrev_b32 v153, 5, v153
  v_add_u32 v151, v151, v153
  v_lshlrev_b32 v152, 2, v145
  v_xor_b32 v152, v152, v146
  v_lshlrev_b32 v152, 4, v152
  v_readfirstlane_b32 s36, v1
  s_and_b32 s40, s2, 7
  s_lshr_b32 s41, s2, 3
  s_and_b32 s42, s40, 1
  s_lshl_b32 s42, s42, 2
  s_and_b32 s43, s41, 3
  s_add_u32 s37, s42, s43
  s_lshr_b32 s42, s40, 1
  s_lshl_b32 s42, s42, 3
  s_lshr_b32 s43, s41, 2
  s_add_u32 s38, s42, s43
  s_lshl_b32 s39, s37, 5
  s_add_u32 s39, s39, s38
  s_lshl_b32 s39, s39, 17
  s_mov_b32 s44, 0x3e0293ee
  s_add_u32 s3, s40, s41
  s_mov_b32 s3, 0
  s_and_b32 s45, s36, 7
  s_and_b32 s46, s45, 3
  s_lshl_b32 s46, s46, 2
  v_add_u32 v154, s46, v145
  v_xor_b32 v154, v154, v146
  v_lshlrev_b32 v154, 4, v154
  v_lshlrev_b32 v155, 8, v145
  s_lshl_b32 s47, s45, 10
  v_add_u32 v155, s47, v155
  v_add_u32 v166, v155, v154
  v_add_u32 v167, v155, v152
  s_lshr_b32 s48, s36, 1
  s_and_b32 s49, s36, 1
  v_xor_b32 v154, v146, v148
  v_lshlrev_b32 v154, 4, v154
  v_lshlrev_b32 v155, 8, v147
  s_lshl_b32 s50, s49, 13
  s_add_u32 s51, s50, 49152
  v_add3_u32 v160, v154, v155, s51
  v_lshlrev_b32 v154, 2, v148
  v_add_u32 v154, v154, v149
  v_lshlrev_b32 v154, 8, v154
  s_lshl_b32 s52, s49, 1
  v_xor_b32 v155, s52, v149
  v_lshlrev_b32 v155, 6, v155
  v_add3_u32 v154, v154, v155, v151
  s_add_u32 s51, s50, 65536
  v_add_u32 v161, s51, v154
  v_lshlrev_b32 v165, 4, v144
  s_and_b32 s55, s36, 3
  v_lshrrev_b32 v20, 3, v144
  s_lshl_b32 s56, s55, 3
  v_add_u32 v20, s56, v20
  v_lshrrev_b32 v21, 1, v20
  v_and_b32 v21, 7, v21
  v_and_b32 v22, 7, v144
  v_xor_b32 v21, v21, v22
  v_lshlrev_b32 v21, 4, v21
  v_mul_u32_u24 v20, 1280, v20
  v_add_u32 v20, v20, v21
  s_lshl_b32 s56, s55, 2
  v_add_u32 v21, s56, v145
  v_lshlrev_b32 v21, 13, v21
  v_add_u32 v21, v21, v152
  s_mul_i32 s57, s37, 245760
  s_lshl_b32 s58, s38, 8
  s_lshl_b32 s59, s55, 10
  s_and_b32 s60, s41, 3
  s_mul_i32 s60, s60, 5
  s_lshr_b32 s60, s60, 1
  s_lshr_b32 s61, s41, 2
  s_mul_i32 s61, s61, 5
  s_lshr_b32 s61, s61, 2
  s_add_u32 s60, s60, s61
  s_sub_u32 s61, s60, 10
  s_cmp_ge_u32 s60, 10
  s_cselect_b32 s56, s61, s60
  s_waitcnt lgkmcnt(0)
  s_mov_b32 s32, s30
  s_and_b32 s33, s31, 0xffff
  s_mov_b32 s34, 268435456
  s_mov_b32 s35, 0x20000
  s_mov_b32 s12, s28
  s_and_b32 s13, s29, 0xffff
  s_mov_b32 s14, 256
  s_mov_b32 s15, 0x20000
  s_mov_b32 s8, s26
  s_and_b32 s9, s27, 0xffff
  s_mov_b32 s10, 1966080
  s_mov_b32 s11, 0x20000
  s_mov_b32 s4, s24
  s_and_b32 s5, s25, 0xffff
  s_mov_b32 s6, 5242880
  s_mov_b32 s7, 0x20000
  s_mov_b32 s28, s22
  s_and_b32 s29, s23, 0xffff
  s_mov_b32 s30, 5242880
  s_mov_b32 s31, 0x20000
  s_mov_b32 s24, s20
  s_and_b32 s25, s21, 0xffff
  s_mov_b32 s26, 33554432
  s_mov_b32 s27, 0x20000
  s_mov_b32 s20, s18
  s_and_b32 s21, s19, 0xffff
  s_mov_b32 s22, 33554432
  s_mov_b32 s23, 0x20000
  s_mov_b32 s16, s16
  s_and_b32 s17, s17, 0xffff
  s_mov_b32 s18, 1966080
  s_mov_b32 s19, 0x20000
  s_cmp_lt_u32 s36, 4
  s_cbranch_scc1 K_cons
  s_cmp_ge_u32 s36, 8
  s_cbranch_scc1 K_prodkv
K_prodx:
  s_lshl_b32 s60, s56, 7
  s_add_u32 s60, s60, s57
  s_add_u32 s53, s60, 0
  s_add_u32 s54, s59, 0
  s_mov_b32 m0, s54
  s_nop 0
  buffer_load_dwordx4 v20, s[16:19], s53 offen lds
  s_add_u32 s53, s60, 40960
  s_add_u32 s54, s59, 4096
  s_mov_b32 m0, s54
  s_nop 0
  buffer_load_dwordx4 v20, s[16:19], s53 offen lds
  s_add_u32 s53, s60, 81920
  s_add_u32 s54, s59, 8192
  s_mov_b32 m0, s54
  s_nop 0
  buffer_load_dwordx4 v20, s[16:19], s53 offen lds
  s_add_u32 s53, s60, 122880
  s_add_u32 s54, s59, 12288
  s_mov_b32 m0, s54
  s_nop 0
  buffer_load_dwordx4 v20, s[16:19], s53 offen lds
  s_add_u32 s53, s60, 163840
  s_add_u32 s54, s59, 16384
  s_mov_b32 m0, s54
  s_nop 0
  buffer_load_dwordx4 v20, s[16:19], s53 offen lds
  s_add_u32 s53, s60, 204800
  s_add_u32 s54, s59, 20480
  s_mov_b32 m0, s54
  s_nop 0
  buffer_load_dwordx4 v20, s[16:19], s53 offen lds
  s_lshl_b32 s60, s56, 19
  s_add_u32 s60, s60, s58
  s_add_u32 s53, s60, 0
  s_add_u32 s54, s59, 98304
  s_mov_b32 m0, s54
  s_nop 0
  buffer_load_dwordx4 v21, s[28:31], s53 offen lds
  s_add_u32 s53, s60, 131072
  s_add_u32 s54, s59, 102400
  s_mov_b32 m0, s54
  s_nop 0
  buffer_load_dwordx4 v21, s[28:31], s53 offen lds
  s_add_u32 s53, s60, 262144
  s_add_u32 s54, s59, 106496
  s_mov_b32 m0, s54
  s_nop 0
  buffer_load_dwordx4 v21, s[28:31], s53 offen lds
  s_add_u32 s53, s60, 393216
  s_add_u32 s54, s59, 110592
  s_mov_b32 m0, s54
  s_nop 0
  buffer_load_dwordx4 v21, s[28:31], s53 offen lds
  s_add_u32 s56, s56, 1
  s_cmp_eq_u32 s56, 10
  s_cselect_b32 s56, 0, s56
  s_lshl_b32 s60, s56, 7
  s_add_u32 s60, s60, s57
  s_add_u32 s53, s60, 0
  s_add_u32 s54, s59, 24576
  s_mov_b32 m0, s54
  s_nop 0
  buffer_load_dwordx4 v20, s[16:19], s53 offen lds
  s_add_u32 s53, s60, 40960
  s_add_u32 s54, s59, 28672
  s_mov_b32 m0, s54
  s_nop 0
  buffer_load_dwordx4 v20, s[16:19], s53 offen lds
  s_add_u32 s53, s60, 81920
  s_add_u32 s54, s59, 32768
  s_mov_b32 m0, s54
  s_nop 0
  buffer_load_dwordx4 v20, s[16:19], s53 offen lds
  s_add_u32 s53, s60, 122880
  s_add_u32 s54, s59, 36864
  s_mov_b32 m0, s54
  s_nop 0
  buffer_load_dwordx4 v20, s[16:19], s53 offen lds
  s_add_u32 s53, s60, 163840
  s_add_u32 s54, s59, 40960
  s_mov_b32 m0, s54
  s_nop 0
  buffer_load_dwordx4 v20, s[16:19], s53 offen lds
  s_add_u32 s53, s60, 204800
  s_add_u32 s54, s59, 45056
  s_mov_b32 m0, s54
  s_nop 0
  buffer_load_dwordx4 v20, s[16:19], s53 offen lds
  s_lshl_b32 s60, s56, 19
  s_add_u32 s60, s60, s58
  s_add_u32 s53, s60, 0
  s_add_u32 s54, s59, 114688
  s_mov_b32 m0, s54
  s_nop 0
  buffer_load_dwordx4 v21, s[28:31], s53 offen lds
  s_add_u32 s53, s60, 131072
  s_add_u32 s54, s59, 118784
  s_mov_b32 m0, s54
  s_nop 0
  buffer_load_dwordx4 v21, s[28:31], s53 offen lds
  s_add_u32 s53, s60, 262144
  s_add_u32 s54, s59, 122880
  s_mov_b32 m0, s54
  s_nop 0
  buffer_load_dwordx4 v21, s[28:31], s53 offen lds
  s_add_u32 s53, s60, 393216
  s_add_u32 s54, s59, 126976
  s_mov_b32 m0, s54
  s_nop 0
  buffer_load_dwordx4 v21, s[28:31], s53 offen lds
  s_add_u32 s56, s56, 1
  s_cmp_eq_u32 s56, 10
  s_cselect_b32 s56, 0, s56
  s_waitcnt vmcnt(10)
  s_barrier
  s_lshl_b32 s60, s56, 7
  s_add_u32 s60, s60, s57
  s_add_u32 s53, s60, 0
  s_add_u32 s54, s59, 49152
  s_mov_b32 m0, s54
  s_nop 0
  buffer_load_dwordx4 v20, s[16:19], s53 offen lds
  s_add_u32 s53, s60, 40960
  s_add_u32 s54, s59, 53248
  s_mov_b32 m0, s54
  s_nop 0
  buffer_load_dwordx4 v20, s[16:19], s53 offen lds
  s_add_u32 s53, s60, 81920
  s_add_u32 s54, s59, 57344
  s_mov_b32 m0, s54
  s_nop 0
  buffer_load_dwordx4 v20, s[16:19], s53 offen lds
  s_add_u32 s53, s60, 122880
  s_add_u32 s54, s59, 61440
  s_mov_b32 m0, s54
  s_nop 0
  buffer_load_dwordx4 v20, s[16:19], s53 offen lds
  s_add_u32 s53, s60, 163840
  s_add_u32 s54, s59, 65536
  s_mov_b32 m0, s54
  s_nop 0
  buffer_load_dwordx4 v20, s[16:19], s53 offen lds
  s_add_u32 s53, s60, 204800
  s_add_u32 s54, s59, 69632
  s_mov_b32 m0, s54
  s_nop 0
  buffer_load_dwordx4 v20, s[16:19], s53 offen lds
  s_lshl_b32 s60, s56, 19
  s_add_u32 s60, s60, s58
  s_add_u32 s53, s60, 0
  s_add_u32 s54, s59, 131072
  s_mov_b32 m0, s54
  s_nop 0
  buffer_load_dwordx4 v21, s[28:31], s53 offen lds
  s_add_u32 s53, s60, 131072
  s_add_u32 s54, s59, 135168
  s_mov_b32 m0, s54
  s_nop 0
  buffer_load_dwordx4 v21, s[28:31], s53 offen lds
  s_add_u32 s53, s60, 262144
  s_add_u32 s54, s59, 139264
  s_mov_b32 m0, s54
  s_nop 0
  buffer_load_dwordx4 v21, s[28:31], s53 offen lds
  s_add_u32 s53, s60, 393216
  s_add_u32 s54, s59, 143360
  s_mov_b32 m0, s54
  s_nop 0
  buffer_load_dwordx4 v21, s[28:31], s53 offen lds
  s_add_u32 s56, s56, 1
  s_cmp_eq_u32 s56, 10
  s_cselect_b32 s56, 0, s56
  s_waitcnt vmcnt(10)
  s_barrier
  s_lshl_b32 s60, s56, 7
  s_add_u32 s60, s60, s57
  s_add_u32 s53, s60, 0
  s_add_u32 s54, s59, 73728
  s_mov_b32 m0, s54
  s_nop 0
  buffer_load_dwordx4 v20, s[16:19], s53 offen lds
  s_add_u32 s53, s60, 40960
  s_add_u32 s54, s59, 77824
  s_mov_b32 m0, s54
  s_nop 0
  buffer_load_dwordx4 v20, s[16:19], s53 offen lds
  s_add_u32 s53, s60, 81920
  s_add_u32 s54, s59, 81920
  s_mov_b32 m0, s54
  s_nop 0
  buffer_load_dwordx4 v20, s[16:19], s53 offen lds
  s_add_u32 s53, s60, 122880
  s_add_u32 s54, s59, 86016
  s_mov_b32 m0, s54
  s_nop 0
  buffer_load_dwordx4 v20, s[16:19], s53 offen lds
  s_add_u32 s53, s60, 163840
  s_add_u32 s54, s59, 90112
  s_mov_b32 m0, s54
  s_nop 0
  buffer_load_dwordx4 v20, s[16:19], s53 offen lds
  s_add_u32 s53, s60, 204800
  s_add_u32 s54, s59, 94208
  s_mov_b32 m0, s54
  s_nop 0
  buffer_load_dwordx4 v20, s[16:19], s53 offen lds
  s_lshl_b32 s60, s56, 19
  s_add_u32 s60, s60, s58
  s_add_u32 s53, s60, 0
  s_add_u32 s54, s59, 147456
  s_mov_b32 m0, s54
  s_nop 0
  buffer_load_dwordx4 v21, s[28:31], s53 offen lds
  s_add_u32 s53, s60, 131072
  s_add_u32 s54, s59, 151552
  s_mov_b32 m0, s54
  s_nop 0
  buffer_load_dwordx4 v21, s[28:31], s53 offen lds
  s_add_u32 s53, s60, 262144
  s_add_u32 s54, s59, 155648
  s_mov_b32 m0, s54
  s_nop 0
  buffer_load_dwordx4 v21, s[28:31], s53 offen lds
  s_add_u32 s53, s60, 393216
  s_add_u32 s54, s59, 159744
  s_mov_b32 m0, s54
  s_nop 0
  buffer_load_dwordx4 v21, s[28:31], s53 offen lds
  s_add_u32 s56, s56, 1
  s_cmp_eq_u32 s56, 10
  s_cselect_b32 s56, 0, s56
  s_waitcnt vmcnt(10)
  s_barrier
  s_lshl_b32 s60, s56, 7
  s_add_u32 s60, s60, s57
  s_add_u32 s53, s60, 0
  s_add_u32 s54, s59, 0
  s_mov_b32 m0, s54
  s_nop 0
  buffer_load_dwordx4 v20, s[16:19], s53 offen lds
  s_add_u32 s53, s60, 40960
  s_add_u32 s54, s59, 4096
  s_mov_b32 m0, s54
  s_nop 0
  buffer_load_dwordx4 v20, s[16:19], s53 offen lds
  s_add_u32 s53, s60, 81920
  s_add_u32 s54, s59, 8192
  s_mov_b32 m0, s54
  s_nop 0
  buffer_load_dwordx4 v20, s[16:19], s53 offen lds
  s_add_u32 s53, s60, 122880
  s_add_u32 s54, s59, 12288
  s_mov_b32 m0, s54
  s_nop 0
  buffer_load_dwordx4 v20, s[16:19], s53 offen lds
  s_add_u32 s53, s60, 163840
  s_add_u32 s54, s59, 16384
  s_mov_b32 m0, s54
  s_nop 0
  buffer_load_dwordx4 v20, s[16:19], s53 offen lds
  s_add_u32 s53, s60, 204800
  s_add_u32 s54, s59, 20480
  s_mov_b32 m0, s54
  s_nop 0
  buffer_load_dwordx4 v20, s[16:19], s53 offen lds
  s_lshl_b32 s60, s56, 19
  s_add_u32 s60, s60, s58
  s_add_u32 s53, s60, 0
  s_add_u32 s54, s59, 98304
  s_mov_b32 m0, s54
  s_nop 0
  buffer_load_dwordx4 v21, s[28:31], s53 offen lds
  s_add_u32 s53, s60, 131072
  s_add_u32 s54, s59, 102400
  s_mov_b32 m0, s54
  s_nop 0
  buffer_load_dwordx4 v21, s[28:31], s53 offen lds
  s_add_u32 s53, s60, 262144
  s_add_u32 s54, s59, 106496
  s_mov_b32 m0, s54
  s_nop 0
  buffer_load_dwordx4 v21, s[28:31], s53 offen lds
  s_add_u32 s53, s60, 393216
  s_add_u32 s54, s59, 110592
  s_mov_b32 m0, s54
  s_nop 0
  buffer_load_dwordx4 v21, s[28:31], s53 offen lds
  s_add_u32 s56, s56, 1
  s_cmp_eq_u32 s56, 10
  s_cselect_b32 s56, 0, s56
  s_waitcnt vmcnt(10)
  s_barrier
  s_lshl_b32 s60, s56, 7
  s_add_u32 s60, s60, s57
  s_add_u32 s53, s60, 0
  s_add_u32 s54, s59, 24576
  s_mov_b32 m0, s54
  s_nop 0
  buffer_load_dwordx4 v20, s[16:19], s53 offen lds
  s_add_u32 s53, s60, 40960
  s_add_u32 s54, s59, 28672
  s_mov_b32 m0, s54
  s_nop 0
  buffer_load_dwordx4 v20, s[16:19], s53 offen lds
  s_add_u32 s53, s60, 81920
  s_add_u32 s54, s59, 32768
  s_mov_b32 m0, s54
  s_nop 0
  buffer_load_dwordx4 v20, s[16:19], s53 offen lds
  s_add_u32 s53, s60, 122880
  s_add_u32 s54, s59, 36864
  s_mov_b32 m0, s54
  s_nop 0
  buffer_load_dwordx4 v20, s[16:19], s53 offen lds
  s_add_u32 s53, s60, 163840
  s_add_u32 s54, s59, 40960
  s_mov_b32 m0, s54
  s_nop 0
  buffer_load_dwordx4 v20, s[16:19], s53 offen lds
  s_add_u32 s53, s60, 204800
  s_add_u32 s54, s59, 45056
  s_mov_b32 m0, s54
  s_nop 0
  buffer_load_dwordx4 v20, s[16:19], s53 offen lds
  s_lshl_b32 s60, s56, 19
  s_add_u32 s60, s60, s58
  s_add_u32 s53, s60, 0
  s_add_u32 s54, s59, 114688
  s_mov_b32 m0, s54
  s_nop 0
  buffer_load_dwordx4 v21, s[28:31], s53 offen lds
  s_add_u32 s53, s60, 131072
  s_add_u32 s54, s59, 118784
  s_mov_b32 m0, s54
  s_nop 0
  buffer_load_dwordx4 v21, s[28:31], s53 offen lds
  s_add_u32 s53, s60, 262144
  s_add_u32 s54, s59, 122880
  s_mov_b32 m0, s54
  s_nop 0
  buffer_load_dwordx4 v21, s[28:31], s53 offen lds
  s_add_u32 s53, s60, 393216
  s_add_u32 s54, s59, 126976
  s_mov_b32 m0, s54
  s_nop 0
  buffer_load_dwordx4 v21, s[28:31], s53 offen lds
  s_add_u32 s56, s56, 1
  s_cmp_eq_u32 s56, 10
  s_cselect_b32 s56, 0, s56
  s_waitcnt vmcnt(10)
  s_barrier
  s_lshl_b32 s60, s56, 7
  s_add_u32 s60, s60, s57
  s_add_u32 s53, s60, 0
  s_add_u32 s54, s59, 49152
  s_mov_b32 m0, s54
  s_nop 0
  buffer_load_dwordx4 v20, s[16:19], s53 offen lds
  s_add_u32 s53, s60, 40960
  s_add_u32 s54, s59, 53248
  s_mov_b32 m0, s54
  s_nop 0
  buffer_load_dwordx4 v20, s[16:19], s53 offen lds
  s_add_u32 s53, s60, 81920
  s_add_u32 s54, s59, 57344
  s_mov_b32 m0, s54
  s_nop 0
  buffer_load_dwordx4 v20, s[16:19], s53 offen lds
  s_add_u32 s53, s60, 122880
  s_add_u32 s54, s59, 61440
  s_mov_b32 m0, s54
  s_nop 0
  buffer_load_dwordx4 v20, s[16:19], s53 offen lds
  s_add_u32 s53, s60, 163840
  s_add_u32 s54, s59, 65536
  s_mov_b32 m0, s54
  s_nop 0
  buffer_load_dwordx4 v20, s[16:19], s53 offen lds
  s_add_u32 s53, s60, 204800
  s_add_u32 s54, s59, 69632
  s_mov_b32 m0, s54
  s_nop 0
  buffer_load_dwordx4 v20, s[16:19], s53 offen lds
  s_lshl_b32 s60, s56, 19
  s_add_u32 s60, s60, s58
  s_add_u32 s53, s60, 0
  s_add_u32 s54, s59, 131072
  s_mov_b32 m0, s54
  s_nop 0
  buffer_load_dwordx4 v21, s[28:31], s53 offen lds
  s_add_u32 s53, s60, 131072
  s_add_u32 s54, s59, 135168
  s_mov_b32 m0, s54
  s_nop 0
  buffer_load_dwordx4 v21, s[28:31], s53 offen lds
  s_add_u32 s53, s60, 262144
  s_add_u32 s54, s59, 139264
  s_mov_b32 m0, s54
  s_nop 0
  buffer_load_dwordx4 v21, s[28:31], s53 offen lds
  s_add_u32 s53, s60, 393216
  s_add_u32 s54, s59, 143360
  s_mov_b32 m0, s54
  s_nop 0
  buffer_load_dwordx4 v21, s[28:31], s53 offen lds
  s_add_u32 s56, s56, 1
  s_cmp_eq_u32 s56, 10
  s_cselect_b32 s56, 0, s56
  s_waitcnt vmcnt(10)
  s_barrier
  s_lshl_b32 s60, s56, 7
  s_add_u32 s60, s60, s57
  s_add_u32 s53, s60, 0
  s_add_u32 s54, s59, 73728
  s_mov_b32 m0, s54
  s_nop 0
  buffer_load_dwordx4 v20, s[16:19], s53 offen lds
  s_add_u32 s53, s60, 40960
  s_add_u32 s54, s59, 77824
  s_mov_b32 m0, s54
  s_nop 0
  buffer_load_dwordx4 v20, s[16:19], s53 offen lds
  s_add_u32 s53, s60, 81920
  s_add_u32 s54, s59, 81920
  s_mov_b32 m0, s54
  s_nop 0
  buffer_load_dwordx4 v20, s[16:19], s53 offen lds
  s_add_u32 s53, s60, 122880
  s_add_u32 s54, s59, 86016
  s_mov_b32 m0, s54
  s_nop 0
  buffer_load_dwordx4 v20, s[16:19], s53 offen lds
  s_add_u32 s53, s60, 163840
  s_add_u32 s54, s59, 90112
  s_mov_b32 m0, s54
  s_nop 0
  buffer_load_dwordx4 v20, s[16:19], s53 offen lds
  s_add_u32 s53, s60, 204800
  s_add_u32 s54, s59, 94208
  s_mov_b32 m0, s54
  s_nop 0
  buffer_load_dwordx4 v20, s[16:19], s53 offen lds
  s_lshl_b32 s60, s56, 19
  s_add_u32 s60, s60, s58
  s_add_u32 s53, s60, 0
  s_add_u32 s54, s59, 147456
  s_mov_b32 m0, s54
  s_nop 0
  buffer_load_dwordx4 v21, s[28:31], s53 offen lds
  s_add_u32 s53, s60, 131072
  s_add_u32 s54, s59, 151552
  s_mov_b32 m0, s54
  s_nop 0
  buffer_load_dwordx4 v21, s[28:31], s53 offen lds
  s_add_u32 s53, s60, 262144
  s_add_u32 s54, s59, 155648
  s_mov_b32 m0, s54
  s_nop 0
  buffer_load_dwordx4 v21, s[28:31], s53 offen lds
  s_add_u32 s53, s60, 393216
  s_add_u32 s54, s59, 159744
  s_mov_b32 m0, s54
  s_nop 0
  buffer_load_dwordx4 v21, s[28:31], s53 offen lds
  s_add_u32 s56, s56, 1
  s_cmp_eq_u32 s56, 10
  s_cselect_b32 s56, 0, s56
  s_waitcnt vmcnt(10)
  s_barrier
  s_lshl_b32 s60, s56, 7
  s_add_u32 s60, s60, s57
  s_add_u32 s53, s60, 0
  s_add_u32 s54, s59, 0
  s_mov_b32 m0, s54
  s_nop 0
  buffer_load_dwordx4 v20, s[16:19], s53 offen lds
  s_add_u32 s53, s60, 40960
  s_add_u32 s54, s59, 4096
  s_mov_b32 m0, s54
  s_nop 0
  buffer_load_dwordx4 v20, s[16:19], s53 offen lds
  s_add_u32 s53, s60, 81920
  s_add_u32 s54, s59, 8192
  s_mov_b32 m0, s54
  s_nop 0
  buffer_load_dwordx4 v20, s[16:19], s53 offen lds
  s_add_u32 s53, s60, 122880
  s_add_u32 s54, s59, 12288
  s_mov_b32 m0, s54
  s_nop 0
  buffer_load_dwordx4 v20, s[16:19], s53 offen lds
  s_add_u32 s53, s60, 163840
  s_add_u32 s54, s59, 16384
  s_mov_b32 m0, s54
  s_nop 0
  buffer_load_dwordx4 v20, s[16:19], s53 offen lds
  s_add_u32 s53, s60, 204800
  s_add_u32 s54, s59, 20480
  s_mov_b32 m0, s54
  s_nop 0
  buffer_load_dwordx4 v20, s[16:19], s53 offen lds
  s_lshl_b32 s60, s56, 19
  s_add_u32 s60, s60, s58
  s_add_u32 s53, s60, 0
  s_add_u32 s54, s59, 98304
  s_mov_b32 m0, s54
  s_nop 0
  buffer_load_dwordx4 v21, s[28:31], s53 offen lds
  s_add_u32 s53, s60, 131072
  s_add_u32 s54, s59, 102400
  s_mov_b32 m0, s54
  s_nop 0
  buffer_load_dwordx4 v21, s[28:31], s53 offen lds
  s_add_u32 s53, s60, 262144
  s_add_u32 s54, s59, 106496
  s_mov_b32 m0, s54
  s_nop 0
  buffer_load_dwordx4 v21, s[28:31], s53 offen lds
  s_add_u32 s53, s60, 393216
  s_add_u32 s54, s59, 110592
  s_mov_b32 m0, s54
  s_nop 0
  buffer_load_dwordx4 v21, s[28:31], s53 offen lds
  s_add_u32 s56, s56, 1
  s_cmp_eq_u32 s56, 10
  s_cselect_b32 s56, 0, s56
  s_waitcnt vmcnt(10)
  s_barrier
  s_lshl_b32 s60, s56, 7
  s_add_u32 s60, s60, s57
  s_add_u32 s53, s60, 0
  s_add_u32 s54, s59, 24576
  s_mov_b32 m0, s54
  s_nop 0
  buffer_load_dwordx4 v20, s[16:19], s53 offen lds
  s_add_u32 s53, s60, 40960
  s_add_u32 s54, s59, 28672
  s_mov_b32 m0, s54
  s_nop 0
  buffer_load_dwordx4 v20, s[16:19], s53 offen lds
  s_add_u32 s53, s60, 81920
  s_add_u32 s54, s59, 32768
  s_mov_b32 m0, s54
  s_nop 0
  buffer_load_dwordx4 v20, s[16:19], s53 offen lds
  s_add_u32 s53, s60, 122880
  s_add_u32 s54, s59, 36864
  s_mov_b32 m0, s54
  s_nop 0
  buffer_load_dwordx4 v20, s[16:19], s53 offen lds
  s_add_u32 s53, s60, 163840
  s_add_u32 s54, s59, 40960
  s_mov_b32 m0, s54
  s_nop 0
  buffer_load_dwordx4 v20, s[16:19], s53 offen lds
  s_add_u32 s53, s60, 204800
  s_add_u32 s54, s59, 45056
  s_mov_b32 m0, s54
  s_nop 0
  buffer_load_dwordx4 v20, s[16:19], s53 offen lds
  s_lshl_b32 s60, s56, 19
  s_add_u32 s60, s60, s58
  s_add_u32 s53, s60, 0
  s_add_u32 s54, s59, 114688
  s_mov_b32 m0, s54
  s_nop 0
  buffer_load_dwordx4 v21, s[28:31], s53 offen lds
  s_add_u32 s53, s60, 131072
  s_add_u32 s54, s59, 118784
  s_mov_b32 m0, s54
  s_nop 0
  buffer_load_dwordx4 v21, s[28:31], s53 offen lds
  s_add_u32 s53, s60, 262144
  s_add_u32 s54, s59, 122880
  s_mov_b32 m0, s54
  s_nop 0
  buffer_load_dwordx4 v21, s[28:31], s53 offen lds
  s_add_u32 s53, s60, 393216
  s_add_u32 s54, s59, 126976
  s_mov_b32 m0, s54
  s_nop 0
  buffer_load_dwordx4 v21, s[28:31], s53 offen lds
  s_add_u32 s56, s56, 1
  s_cmp_eq_u32 s56, 10
  s_cselect_b32 s56, 0, s56
  s_waitcnt vmcnt(0)
  s_barrier
  s_barrier
  s_branch K_qx
K_prodkv:
  s_cmp_eq_u32 s36, 9
  s_cbranch_scc0 K_ncw
  s_cmp_lt_u32 s41, (K_codeend-standalone__mha_block_cached__near_ridge_kernel+8191)/8192
  s_cbranch_scc0 K_ncw
  s_getpc_b64 s[60:61]
K_pcref:
  s_sub_u32 s60, s60, K_pcref-standalone__mha_block_cached__near_ridge_kernel
  s_subb_u32 s61, s61, 0
  s_lshl_b32 s62, s41, 13
  s_min_u32 s62, s62, K_codeend-standalone__mha_block_cached__near_ridge_kernel-8192
  s_add_u32 s60, s60, s62
  s_addc_u32 s61, s61, 0
  v_lshlrev_b32 v1, 7, v144
  global_load_dword v3, v1, s[60:61]
K_ncw:
  s_cmp_eq_u32 s36, 8
  s_cbranch_scc0 K_nz
  s_cmp_lt_u32 s2, 92
  s_cbranch_scc0 K_nz
  s_lshl_b32 s55, s2, 8
  s_add_u32 s55, s55, 50331648
  v_mov_b32 v1, 0
  v_mov_b32 v2, 1
  s_mov_b64 exec, 1
  buffer_store_dword v1, off, s[32:35], s55 sc1
  s_mov_b64 exec, -1
K_nz:
  s_barrier
  s_barrier
  s_barrier
  s_barrier
  s_barrier
  s_barrier
  s_waitcnt vmcnt(0)
  s_cmp_eq_u32 s36, 8
  s_cbranch_scc0 K_nz2
  s_cmp_lt_u32 s2, 92
  s_cbranch_scc0 K_nz2
  s_mov_b64 exec, 1
  buffer_atomic_add v2, off, s[12:15], 0 offset:240 sc1
  s_mov_b64 exec, -1
K_nz2:
  s_barrier
  s_barrier
  s_barrier
  s_add_u32 s53, s3, 0
  s_and_b32 s53, s53, 7
  s_lshl_b32 s53, s53, 14
  s_add_u32 s53, s53, s39
  s_add_u32 s54, s47, 49152
  s_mov_b32 m0, s54
  s_nop 0
  buffer_load_dwordx4 v166, s[20:23], s53 offen nt lds
  s_add_u32 s53, s3, 0
  s_and_b32 s53, s53, 7
  s_lshl_b32 s53, s53, 14
  s_add_u32 s53, s53, s39
  s_add_u32 s53, s53, 4096
  s_add_u32 s54, s47, 53248
  s_mov_b32 m0, s54
  s_nop 0
  buffer_load_dwordx4 v166, s[20:23], s53 offen nt lds
  s_add_u32 s53, s3, 0
  s_and_b32 s53, s53, 7
  s_lshl_b32 s53, s53, 14
  s_add_u32 s53, s53, s39
  s_add_u32 s53, s53, 8192
  s_add_u32 s54, s47, 57344
  s_mov_b32 m0, s54
  s_nop 0
  buffer_load_dwordx4 v166, s[20:23], s53 offen nt lds
  s_add_u32 s53, s3, 0
  s_and_b32 s53, s53, 7
  s_lshl_b32 s53, s53, 14
  s_add_u32 s53, s53, s39
  s_add_u32 s53, s53, 12288
  s_add_u32 s54, s47, 61440
  s_mov_b32 m0, s54
  s_nop 0
  buffer_load_dwordx4 v166, s[20:23], s53 offen nt lds
  s_add_u32 s53, s3, 1
  s_and_b32 s53, s53, 7
  s_lshl_b32 s53, s53, 14
  s_add_u32 s53, s53, s39
  s_add_u32 s54, s47, 131072
  s_mov_b32 m0, s54
  s_nop 0
  buffer_load_dwordx4 v166, s[20:23], s53 offen nt lds
  s_add_u32 s53, s3, 1
  s_and_b32 s53, s53, 7
  s_lshl_b32 s53, s53, 14
  s_add_u32 s53, s53, s39
  s_add_u32 s53, s53, 4096
  s_add_u32 s54, s47, 135168
  s_mov_b32 m0, s54
  s_nop 0
  buffer_load_dwordx4 v166, s[20:23], s53 offen nt lds
  s_add_u32 s53, s3, 1
  s_and_b32 s53, s53, 7
  s_lshl_b32 s53, s53, 14
  s_add_u32 s53, s53, s39
  s_add_u32 s53, s53, 8192
  s_add_u32 s54, s47, 139264
  s_mov_b32 m0, s54
  s_nop 0
  buffer_load_dwordx4 v166, s[20:23], s53 offen nt lds
  s_add_u32 s53, s3, 1
  s_and_b32 s53, s53, 7
  s_lshl_b32 s53, s53, 14
  s_add_u32 s53, s53, s39
  s_add_u32 s53, s53, 12288
  s_add_u32 s54, s47, 143360
  s_mov_b32 m0, s54
  s_nop 0
  buffer_load_dwordx4 v166, s[20:23], s53 offen nt lds
  s_barrier
  s_add_u32 s53, s3, 0
  s_and_b32 s53, s53, 7
  s_lshl_b32 s53, s53, 14
  s_add_u32 s53, s53, s39
  s_add_u32 s54, s47, 65536
  s_mov_b32 m0, s54
  s_nop 0
  buffer_load_dwordx4 v167, s[24:27], s53 offen nt lds
  s_add_u32 s53, s3, 0
  s_and_b32 s53, s53, 7
  s_lshl_b32 s53, s53, 14
  s_add_u32 s53, s53, s39
  s_add_u32 s53, s53, 4096
  s_add_u32 s54, s47, 69632
  s_mov_b32 m0, s54
  s_nop 0
  buffer_load_dwordx4 v167, s[24:27], s53 offen nt lds
  s_add_u32 s53, s3, 0
  s_and_b32 s53, s53, 7
  s_lshl_b32 s53, s53, 14
  s_add_u32 s53, s53, s39
  s_add_u32 s53, s53, 8192
  s_add_u32 s54, s47, 73728
  s_mov_b32 m0, s54
  s_nop 0
  buffer_load_dwordx4 v167, s[24:27], s53 offen nt lds
  s_add_u32 s53, s3, 0
  s_and_b32 s53, s53, 7
  s_lshl_b32 s53, s53, 14
  s_add_u32 s53, s53, s39
  s_add_u32 s53, s53, 12288
  s_add_u32 s54, s47, 77824
  s_mov_b32 m0, s54
  s_nop 0
  buffer_load_dwordx4 v167, s[24:27], s53 offen nt lds
  s_add_u32 s53, s3, 2
  s_and_b32 s53, s53, 7
  s_lshl_b32 s53, s53, 14
  s_add_u32 s53, s53, s39
  s_add_u32 s54, s47, 81920
  s_mov_b32 m0, s54
  s_nop 0
  buffer_load_dwordx4 v166, s[20:23], s53 offen nt lds
  s_add_u32 s53, s3, 2
  s_and_b32 s53, s53, 7
  s_lshl_b32 s53, s53, 14
  s_add_u32 s53, s53, s39
  s_add_u32 s53, s53, 4096
  s_add_u32 s54, s47, 86016
  s_mov_b32 m0, s54
  s_nop 0
  buffer_load_dwordx4 v166, s[20:23], s53 offen nt lds
  s_add_u32 s53, s3, 2
  s_and_b32 s53, s53, 7
  s_lshl_b32 s53, s53, 14
  s_add_u32 s53, s53, s39
  s_add_u32 s53, s53, 8192
  s_add_u32 s54, s47, 90112
  s_mov_b32 m0, s54
  s_nop 0
  buffer_load_dwordx4 v166, s[20:23], s53 offen nt lds
  s_add_u32 s53, s3, 2
  s_and_b32 s53, s53, 7
  s_lshl_b32 s53, s53, 14
  s_add_u32 s53, s53, s39
  s_add_u32 s53, s53, 12288
  s_add_u32 s54, s47, 94208
  s_mov_b32 m0, s54
  s_nop 0
  buffer_load_dwordx4 v166, s[20:23], s53 offen nt lds
  s_waitcnt vmcnt(8)
  s_branch K_qx
K_cons:
  v_lshrrev_b32 v154, 1, v146
  v_xor_b32 v154, v154, v148
  v_lshlrev_b32 v154, 4, v154
  v_lshlrev_b32 v155, 7, v147
  s_mul_i32 s55, s48, 12288
  v_add3_u32 v136, v154, v155, s55
  v_xor_b32 v137, 32, v136
  v_xor_b32 v162, 64, v136
  v_xor_b32 v163, 96, v136
  v_lshlrev_b32 v154, 3, v148
  v_add_u32 v154, v154, v149
  v_lshlrev_b32 v154, 8, v154
  v_xor_b32 v155, s52, v149
  v_lshlrev_b32 v155, 6, v155
  v_add3_u32 v154, v154, v155, v151
  v_add_u32 v138, 98304, v154
  v_xor_b32 v139, 64, v138
  s_barrier
  ds_read_b64_tr_b16 v[96:97], v138 offset:0
  ds_read_b64_tr_b16 v[98:99], v138 offset:1024
  ds_read_b64_tr_b16 v[100:101], v139 offset:0
  ds_read_b64_tr_b16 v[102:103], v139 offset:1024
  ds_read_b128 v[104:107], v136 offset:0
  ds_read_b128 v[108:111], v136 offset:4096
  ds_read_b128 v[112:115], v136 offset:8192
  v_add_u32 v136, 0x6000, v136
  ds_read_b64_tr_b16 v[116:117], v138 offset:4096
  ds_read_b64_tr_b16 v[118:119], v138 offset:5120
  ds_read_b64_tr_b16 v[120:121], v139 offset:4096
  ds_read_b64_tr_b16 v[122:123], v139 offset:5120
  ds_read_b128 v[124:127], v137 offset:0
  ds_read_b128 v[128:131], v137 offset:4096
  ds_read_b128 v[132:135], v137 offset:8192
  v_add_u32 v137, 0x6000, v137
  s_waitcnt lgkmcnt(7)
  v_mfma_f32_32x32x16_bf16 v[0:15], v[96:99], v[104:107], 0
  ds_read_b64_tr_b16 v[140:141], v138 offset:8192
  ds_read_b64_tr_b16 v[142:143], v138 offset:9216
  v_mfma_f32_32x32x16_bf16 v[16:31], v[96:99], v[108:111], 0
  ds_read_b64_tr_b16 v[144:145], v139 offset:8192
  v_mfma_f32_32x32x16_bf16 v[32:47], v[96:99], v[112:115], 0
  ds_read_b64_tr_b16 v[146:147], v139 offset:9216
  v_mfma_f32_32x32x16_bf16 v[48:63], v[100:103], v[104:107], 0
  ds_read_b128 v[148:151], v162 offset:0
  v_mfma_f32_32x32x16_bf16 v[64:79], v[100:103], v[108:111], 0
  ds_read_b128 v[152:155], v162 offset:4096
  v_mfma_f32_32x32x16_bf16 v[80:95], v[100:103], v[112:115], 0
  ds_read_b128 v[156:159], v162 offset:8192
  v_add_u32 v162, 0x6000, v162
  s_waitcnt lgkmcnt(7)
  v_mfma_f32_32x32x16_bf16 v[0:15], v[116:119], v[124:127], v[0:15]
  ds_read_b64_tr_b16 v[96:97], v138 offset:12288
  ds_read_b64_tr_b16 v[98:99], v138 offset:13312
  v_mfma_f32_32x32x16_bf16 v[16:31], v[116:119], v[128:131], v[16:31]
  ds_read_b64_tr_b16 v[100:101], v139 offset:12288
  v_mfma_f32_32x32x16_bf16 v[32:47], v[116:119], v[132:135], v[32:47]
  ds_read_b64_tr_b16 v[102:103], v139 offset:13312
  v_mfma_f32_32x32x16_bf16 v[48:63], v[120:123], v[124:127], v[48:63]
  ds_read_b128 v[104:107], v163 offset:0
  v_mfma_f32_32x32x16_bf16 v[64:79], v[120:123], v[128:131], v[64:79]
  ds_read_b128 v[108:111], v163 offset:4096
  v_mfma_f32_32x32x16_bf16 v[80:95], v[120:123], v[132:135], v[80:95]
  ds_read_b128 v[112:115], v163 offset:8192
  v_add_u32 v163, 0x6000, v163
  s_waitcnt lgkmcnt(7)
  s_barrier
  v_mfma_f32_32x32x16_bf16 v[0:15], v[140:143], v[148:151], v[0:15]
  ds_read_b64_tr_b16 v[116:117], v138 offset:16384
  ds_read_b64_tr_b16 v[118:119], v138 offset:17408
  v_mfma_f32_32x32x16_bf16 v[16:31], v[140:143], v[152:155], v[16:31]
  ds_read_b64_tr_b16 v[120:121], v139 offset:16384
  v_mfma_f32_32x32x16_bf16 v[32:47], v[140:143], v[156:159], v[32:47]
  ds_read_b64_tr_b16 v[122:123], v139 offset:17408
  v_mfma_f32_32x32x16_bf16 v[48:63], v[144:147], v[148:151], v[48:63]
  ds_read_b128 v[124:127], v136 offset:0
  v_mfma_f32_32x32x16_bf16 v[64:79], v[144:147], v[152:155], v[64:79]
  ds_read_b128 v[128:131], v136 offset:4096
  v_mfma_f32_32x32x16_bf16 v[80:95], v[144:147], v[156:159], v[80:95]
  ds_read_b128 v[132:135], v136 offset:8192
  v_add_u32 v136, 0x6000, v136
  s_waitcnt lgkmcnt(7)
  v_mfma_f32_32x32x16_bf16 v[0:15], v[96:99], v[104:107], v[0:15]
  ds_read_b64_tr_b16 v[140:141], v138 offset:20480
  ds_read_b64_tr_b16 v[142:143], v138 offset:21504
  v_mfma_f32_32x32x16_bf16 v[16:31], v[96:99], v[108:111], v[16:31]
  ds_read_b64_tr_b16 v[144:145], v139 offset:20480
  v_mfma_f32_32x32x16_bf16 v[32:47], v[96:99], v[112:115], v[32:47]
  ds_read_b64_tr_b16 v[146:147], v139 offset:21504
  v_mfma_f32_32x32x16_bf16 v[48:63], v[100:103], v[104:107], v[48:63]
  ds_read_b128 v[148:151], v137 offset:0
  v_mfma_f32_32x32x16_bf16 v[64:79], v[100:103], v[108:111], v[64:79]
  ds_read_b128 v[152:155], v137 offset:4096
  v_mfma_f32_32x32x16_bf16 v[80:95], v[100:103], v[112:115], v[80:95]
  ds_read_b128 v[156:159], v137 offset:8192
  v_add_u32 v137, 0x6000, v137
  s_waitcnt lgkmcnt(7)
  v_mfma_f32_32x32x16_bf16 v[0:15], v[116:119], v[124:127], v[0:15]
  ds_read_b64_tr_b16 v[96:97], v138 offset:24576
  ds_read_b64_tr_b16 v[98:99], v138 offset:25600
  v_mfma_f32_32x32x16_bf16 v[16:31], v[116:119], v[128:131], v[16:31]
  ds_read_b64_tr_b16 v[100:101], v139 offset:24576
  v_mfma_f32_32x32x16_bf16 v[32:47], v[116:119], v[132:135], v[32:47]
  ds_read_b64_tr_b16 v[102:103], v139 offset:25600
  v_mfma_f32_32x32x16_bf16 v[48:63], v[120:123], v[124:127], v[48:63]
  ds_read_b128 v[104:107], v162 offset:0
  v_mfma_f32_32x32x16_bf16 v[64:79], v[120:123], v[128:131], v[64:79]
  ds_read_b128 v[108:111], v162 offset:4096
  v_mfma_f32_32x32x16_bf16 v[80:95], v[120:123], v[132:135], v[80:95]
  ds_read_b128 v[112:115], v162 offset:8192
  v_add_u32 v162, 0x6000, v162
  s_waitcnt lgkmcnt(7)
  v_mfma_f32_32x32x16_bf16 v[0:15], v[140:143], v[148:151], v[0:15]
  ds_read_b64_tr_b16 v[116:117], v138 offset:28672
  ds_read_b64_tr_b16 v[118:119], v138 offset:29696
  v_mfma_f32_32x32x16_bf16 v[16:31], v[140:143], v[152:155], v[16:31]
  ds_read_b64_tr_b16 v[120:121], v139 offset:28672
  v_mfma_f32_32x32x16_bf16 v[32:47], v[140:143], v[156:159], v[32:47]
  ds_read_b64_tr_b16 v[122:123], v139 offset:29696
  v_mfma_f32_32x32x16_bf16 v[48:63], v[144:147], v[148:151], v[48:63]
  ds_read_b128 v[124:127], v163 offset:0
  v_mfma_f32_32x32x16_bf16 v[64:79], v[144:147], v[152:155], v[64:79]
  ds_read_b128 v[128:131], v163 offset:4096
  v_mfma_f32_32x32x16_bf16 v[80:95], v[144:147], v[156:159], v[80:95]
  ds_read_b128 v[132:135], v163 offset:8192
  v_add_u32 v163, 0x6000, v163
  s_waitcnt lgkmcnt(7)
  s_barrier
  v_mfma_f32_32x32x16_bf16 v[0:15], v[96:99], v[104:107], v[0:15]
  ds_read_b64_tr_b16 v[140:141], v138 offset:32768
  ds_read_b64_tr_b16 v[142:143], v138 offset:33792
  v_mfma_f32_32x32x16_bf16 v[16:31], v[96:99], v[108:111], v[16:31]
  ds_read_b64_tr_b16 v[144:145], v139 offset:32768
  v_mfma_f32_32x32x16_bf16 v[32:47], v[96:99], v[112:115], v[32:47]
  ds_read_b64_tr_b16 v[146:147], v139 offset:33792
  v_mfma_f32_32x32x16_bf16 v[48:63], v[100:103], v[104:107], v[48:63]
  ds_read_b128 v[148:151], v136 offset:0
  v_mfma_f32_32x32x16_bf16 v[64:79], v[100:103], v[108:111], v[64:79]
  ds_read_b128 v[152:155], v136 offset:4096
  v_mfma_f32_32x32x16_bf16 v[80:95], v[100:103], v[112:115], v[80:95]
  ds_read_b128 v[156:159], v136 offset:8192
  v_add_u32 v136, 0x6000, v136
  s_waitcnt lgkmcnt(7)
  v_mfma_f32_32x32x16_bf16 v[0:15], v[116:119], v[124:127], v[0:15]
  ds_read_b64_tr_b16 v[96:97], v138 offset:36864
  ds_read_b64_tr_b16 v[98:99], v138 offset:37888
  v_mfma_f32_32x32x16_bf16 v[16:31], v[116:119], v[128:131], v[16:31]
  ds_read_b64_tr_b16 v[100:101], v139 offset:36864
  v_mfma_f32_32x32x16_bf16 v[32:47], v[116:119], v[132:135], v[32:47]
  ds_read_b64_tr_b16 v[102:103], v139 offset:37888
  v_mfma_f32_32x32x16_bf16 v[48:63], v[120:123], v[124:127], v[48:63]
  ds_read_b128 v[104:107], v137 offset:0
  v_mfma_f32_32x32x16_bf16 v[64:79], v[120:123], v[128:131], v[64:79]
  ds_read_b128 v[108:111], v137 offset:4096
  v_mfma_f32_32x32x16_bf16 v[80:95], v[120:123], v[132:135], v[80:95]
  ds_read_b128 v[112:115], v137 offset:8192
  v_add_u32 v137, 0x6000, v137
  s_waitcnt lgkmcnt(7)
  v_mfma_f32_32x32x16_bf16 v[0:15], v[140:143], v[148:151], v[0:15]
  ds_read_b64_tr_b16 v[116:117], v138 offset:40960
  ds_read_b64_tr_b16 v[118:119], v138 offset:41984
  v_mfma_f32_32x32x16_bf16 v[16:31], v[140:143], v[152:155], v[16:31]
  ds_read_b64_tr_b16 v[120:121], v139 offset:40960
  v_mfma_f32_32x32x16_bf16 v[32:47], v[140:143], v[156:159], v[32:47]
  ds_read_b64_tr_b16 v[122:123], v139 offset:41984
  v_mfma_f32_32x32x16_bf16 v[48:63], v[144:147], v[148:151], v[48:63]
  ds_read_b128 v[124:127], v162 offset:0
  v_mfma_f32_32x32x16_bf16 v[64:79], v[144:147], v[152:155], v[64:79]
  ds_read_b128 v[128:131], v162 offset:4096
  v_mfma_f32_32x32x16_bf16 v[80:95], v[144:147], v[156:159], v[80:95]
  ds_read_b128 v[132:135], v162 offset:8192
  v_add_u32 v162, 0x6000, v162
  s_waitcnt lgkmcnt(7)
  v_mfma_f32_32x32x16_bf16 v[0:15], v[96:99], v[104:107], v[0:15]
  ds_read_b64_tr_b16 v[140:141], v138 offset:45056
  ds_read_b64_tr_b16 v[142:143], v138 offset:46080
  v_mfma_f32_32x32x16_bf16 v[16:31], v[96:99], v[108:111], v[16:31]
  ds_read_b64_tr_b16 v[144:145], v139 offset:45056
  v_mfma_f32_32x32x16_bf16 v[32:47], v[96:99], v[112:115], v[32:47]
  ds_read_b64_tr_b16 v[146:147], v139 offset:46080
  v_mfma_f32_32x32x16_bf16 v[48:63], v[100:103], v[104:107], v[48:63]
  ds_read_b128 v[148:151], v163 offset:0
  v_mfma_f32_32x32x16_bf16 v[64:79], v[100:103], v[108:111], v[64:79]
  ds_read_b128 v[152:155], v163 offset:4096
  v_mfma_f32_32x32x16_bf16 v[80:95], v[100:103], v[112:115], v[80:95]
  ds_read_b128 v[156:159], v163 offset:8192
  v_add_u32 v163, 0x6000, v163
  s_waitcnt lgkmcnt(7)
  s_barrier
  v_mfma_f32_32x32x16_bf16 v[0:15], v[116:119], v[124:127], v[0:15]
  ds_read_b64_tr_b16 v[96:97], v138 offset:49152
  ds_read_b64_tr_b16 v[98:99], v138 offset:50176
  v_mfma_f32_32x32x16_bf16 v[16:31], v[116:119], v[128:131], v[16:31]
  ds_read_b64_tr_b16 v[100:101], v139 offset:49152
  v_mfma_f32_32x32x16_bf16 v[32:47], v[116:119], v[132:135], v[32:47]
  ds_read_b64_tr_b16 v[102:103], v139 offset:50176
  v_mfma_f32_32x32x16_bf16 v[48:63], v[120:123], v[124:127], v[48:63]
  ds_read_b128 v[104:107], v136 offset:0
  v_mfma_f32_32x32x16_bf16 v[64:79], v[120:123], v[128:131], v[64:79]
  ds_read_b128 v[108:111], v136 offset:4096
  v_mfma_f32_32x32x16_bf16 v[80:95], v[120:123], v[132:135], v[80:95]
  ds_read_b128 v[112:115], v136 offset:8192
  v_add_u32 v136, 0xfffee000, v136
  s_waitcnt lgkmcnt(7)
  v_mfma_f32_32x32x16_bf16 v[0:15], v[140:143], v[148:151], v[0:15]
  ds_read_b64_tr_b16 v[116:117], v138 offset:53248
  ds_read_b64_tr_b16 v[118:119], v138 offset:54272
  v_mfma_f32_32x32x16_bf16 v[16:31], v[140:143], v[152:155], v[16:31]
  ds_read_b64_tr_b16 v[120:121], v139 offset:53248
  v_mfma_f32_32x32x16_bf16 v[32:47], v[140:143], v[156:159], v[32:47]
  ds_read_b64_tr_b16 v[122:123], v139 offset:54272
  v_mfma_f32_32x32x16_bf16 v[48:63], v[144:147], v[148:151], v[48:63]
  ds_read_b128 v[124:127], v137 offset:0
  v_mfma_f32_32x32x16_bf16 v[64:79], v[144:147], v[152:155], v[64:79]
  ds_read_b128 v[128:131], v137 offset:4096
  v_mfma_f32_32x32x16_bf16 v[80:95], v[144:147], v[156:159], v[80:95]
  ds_read_b128 v[132:135], v137 offset:8192
  v_add_u32 v137, 0xfffee000, v137
  s_waitcnt lgkmcnt(7)
  v_mfma_f32_32x32x16_bf16 v[0:15], v[96:99], v[104:107], v[0:15]
  ds_read_b64_tr_b16 v[140:141], v138 offset:57344
  ds_read_b64_tr_b16 v[142:143], v138 offset:58368
  v_mfma_f32_32x32x16_bf16 v[16:31], v[96:99], v[108:111], v[16:31]
  ds_read_b64_tr_b16 v[144:145], v139 offset:57344
  v_mfma_f32_32x32x16_bf16 v[32:47], v[96:99], v[112:115], v[32:47]
  ds_read_b64_tr_b16 v[146:147], v139 offset:58368
  v_mfma_f32_32x32x16_bf16 v[48:63], v[100:103], v[104:107], v[48:63]
  ds_read_b128 v[148:151], v162 offset:0
  v_mfma_f32_32x32x16_bf16 v[64:79], v[100:103], v[108:111], v[64:79]
  ds_read_b128 v[152:155], v162 offset:4096
  v_mfma_f32_32x32x16_bf16 v[80:95], v[100:103], v[112:115], v[80:95]
  ds_read_b128 v[156:159], v162 offset:8192
  v_add_u32 v162, 0xfffee000, v162
  s_waitcnt lgkmcnt(7)
  v_mfma_f32_32x32x16_bf16 v[0:15], v[116:119], v[124:127], v[0:15]
  ds_read_b64_tr_b16 v[96:97], v138 offset:61440
  ds_read_b64_tr_b16 v[98:99], v138 offset:62464
  v_mfma_f32_32x32x16_bf16 v[16:31], v[116:119], v[128:131], v[16:31]
  ds_read_b64_tr_b16 v[100:101], v139 offset:61440
  v_mfma_f32_32x32x16_bf16 v[32:47], v[116:119], v[132:135], v[32:47]
  ds_read_b64_tr_b16 v[102:103], v139 offset:62464
  v_mfma_f32_32x32x16_bf16 v[48:63], v[120:123], v[124:127], v[48:63]
  ds_read_b128 v[104:107], v163 offset:0
  v_mfma_f32_32x32x16_bf16 v[64:79], v[120:123], v[128:131], v[64:79]
  ds_read_b128 v[108:111], v163 offset:4096
  v_mfma_f32_32x32x16_bf16 v[80:95], v[120:123], v[132:135], v[80:95]
  ds_read_b128 v[112:115], v163 offset:8192
  v_add_u32 v163, 0xfffee000, v163
  s_waitcnt lgkmcnt(7)
  s_barrier
  v_mfma_f32_32x32x16_bf16 v[0:15], v[140:143], v[148:151], v[0:15]
  ds_read_b64_tr_b16 v[116:117], v138 offset:0
  ds_read_b64_tr_b16 v[118:119], v138 offset:1024
  v_mfma_f32_32x32x16_bf16 v[16:31], v[140:143], v[152:155], v[16:31]
  ds_read_b64_tr_b16 v[120:121], v139 offset:0
  v_mfma_f32_32x32x16_bf16 v[32:47], v[140:143], v[156:159], v[32:47]
  ds_read_b64_tr_b16 v[122:123], v139 offset:1024
  v_mfma_f32_32x32x16_bf16 v[48:63], v[144:147], v[148:151], v[48:63]
  ds_read_b128 v[124:127], v136 offset:0
  v_mfma_f32_32x32x16_bf16 v[64:79], v[144:147], v[152:155], v[64:79]
  ds_read_b128 v[128:131], v136 offset:4096
  v_mfma_f32_32x32x16_bf16 v[80:95], v[144:147], v[156:159], v[80:95]
  ds_read_b128 v[132:135], v136 offset:8192
  v_add_u32 v136, 0x6000, v136
  s_waitcnt lgkmcnt(7)
  v_mfma_f32_32x32x16_bf16 v[0:15], v[96:99], v[104:107], v[0:15]
  ds_read_b64_tr_b16 v[140:141], v138 offset:4096
  ds_read_b64_tr_b16 v[142:143], v138 offset:5120
  v_mfma_f32_32x32x16_bf16 v[16:31], v[96:99], v[108:111], v[16:31]
  ds_read_b64_tr_b16 v[144:145], v139 offset:4096
  v_mfma_f32_32x32x16_bf16 v[32:47], v[96:99], v[112:115], v[32:47]
  ds_read_b64_tr_b16 v[146:147], v139 offset:5120
  v_mfma_f32_32x32x16_bf16 v[48:63], v[100:103], v[104:107], v[48:63]
  ds_read_b128 v[148:151], v137 offset:0
  v_mfma_f32_32x32x16_bf16 v[64:79], v[100:103], v[108:111], v[64:79]
  ds_read_b128 v[152:155], v137 offset:4096
  v_mfma_f32_32x32x16_bf16 v[80:95], v[100:103], v[112:115], v[80:95]
  ds_read_b128 v[156:159], v137 offset:8192
  v_add_u32 v137, 0x6000, v137
  s_waitcnt lgkmcnt(7)
  v_mfma_f32_32x32x16_bf16 v[0:15], v[116:119], v[124:127], v[0:15]
  ds_read_b64_tr_b16 v[96:97], v138 offset:8192
  ds_read_b64_tr_b16 v[98:99], v138 offset:9216
  v_mfma_f32_32x32x16_bf16 v[16:31], v[116:119], v[128:131], v[16:31]
  ds_read_b64_tr_b16 v[100:101], v139 offset:8192
  v_mfma_f32_32x32x16_bf16 v[32:47], v[116:119], v[132:135], v[32:47]
  ds_read_b64_tr_b16 v[102:103], v139 offset:9216
  v_mfma_f32_32x32x16_bf16 v[48:63], v[120:123], v[124:127], v[48:63]
  ds_read_b128 v[104:107], v162 offset:0
  v_mfma_f32_32x32x16_bf16 v[64:79], v[120:123], v[128:131], v[64:79]
  ds_read_b128 v[108:111], v162 offset:4096
  v_mfma_f32_32x32x16_bf16 v[80:95], v[120:123], v[132:135], v[80:95]
  ds_read_b128 v[112:115], v162 offset:8192
  v_add_u32 v162, 0x6000, v162
  s_waitcnt lgkmcnt(7)
  v_mfma_f32_32x32x16_bf16 v[0:15], v[140:143], v[148:151], v[0:15]
  ds_read_b64_tr_b16 v[116:117], v138 offset:12288
  ds_read_b64_tr_b16 v[118:119], v138 offset:13312
  v_mfma_f32_32x32x16_bf16 v[16:31], v[140:143], v[152:155], v[16:31]
  ds_read_b64_tr_b16 v[120:121], v139 offset:12288
  v_mfma_f32_32x32x16_bf16 v[32:47], v[140:143], v[156:159], v[32:47]
  ds_read_b64_tr_b16 v[122:123], v139 offset:13312
  v_mfma_f32_32x32x16_bf16 v[48:63], v[144:147], v[148:151], v[48:63]
  ds_read_b128 v[124:127], v163 offset:0
  v_mfma_f32_32x32x16_bf16 v[64:79], v[144:147], v[152:155], v[64:79]
  ds_read_b128 v[128:131], v163 offset:4096
  v_mfma_f32_32x32x16_bf16 v[80:95], v[144:147], v[156:159], v[80:95]
  ds_read_b128 v[132:135], v163 offset:8192
  v_add_u32 v163, 0x6000, v163
  s_waitcnt lgkmcnt(7)
  s_barrier
  v_mfma_f32_32x32x16_bf16 v[0:15], v[96:99], v[104:107], v[0:15]
  ds_read_b64_tr_b16 v[140:141], v138 offset:16384
  ds_read_b64_tr_b16 v[142:143], v138 offset:17408
  v_mfma_f32_32x32x16_bf16 v[16:31], v[96:99], v[108:111], v[16:31]
  ds_read_b64_tr_b16 v[144:145], v139 offset:16384
  v_mfma_f32_32x32x16_bf16 v[32:47], v[96:99], v[112:115], v[32:47]
  ds_read_b64_tr_b16 v[146:147], v139 offset:17408
  v_mfma_f32_32x32x16_bf16 v[48:63], v[100:103], v[104:107], v[48:63]
  ds_read_b128 v[148:151], v136 offset:0
  v_mfma_f32_32x32x16_bf16 v[64:79], v[100:103], v[108:111], v[64:79]
  ds_read_b128 v[152:155], v136 offset:4096
  v_mfma_f32_32x32x16_bf16 v[80:95], v[100:103], v[112:115], v[80:95]
  ds_read_b128 v[156:159], v136 offset:8192
  v_add_u32 v136, 0x6000, v136
  s_waitcnt lgkmcnt(7)
  v_mfma_f32_32x32x16_bf16 v[0:15], v[116:119], v[124:127], v[0:15]
  ds_read_b64_tr_b16 v[96:97], v138 offset:20480
  ds_read_b64_tr_b16 v[98:99], v138 offset:21504
  v_mfma_f32_32x32x16_bf16 v[16:31], v[116:119], v[128:131], v[16:31]
  ds_read_b64_tr_b16 v[100:101], v139 offset:20480
  v_mfma_f32_32x32x16_bf16 v[32:47], v[116:119], v[132:135], v[32:47]
  ds_read_b64_tr_b16 v[102:103], v139 offset:21504
  v_mfma_f32_32x32x16_bf16 v[48:63], v[120:123], v[124:127], v[48:63]
  ds_read_b128 v[104:107], v137 offset:0
  v_mfma_f32_32x32x16_bf16 v[64:79], v[120:123], v[128:131], v[64:79]
  ds_read_b128 v[108:111], v137 offset:4096
  v_mfma_f32_32x32x16_bf16 v[80:95], v[120:123], v[132:135], v[80:95]
  ds_read_b128 v[112:115], v137 offset:8192
  v_add_u32 v137, 0x6000, v137
  s_waitcnt lgkmcnt(7)
  v_mfma_f32_32x32x16_bf16 v[0:15], v[140:143], v[148:151], v[0:15]
  ds_read_b64_tr_b16 v[116:117], v138 offset:24576
  ds_read_b64_tr_b16 v[118:119], v138 offset:25600
  v_mfma_f32_32x32x16_bf16 v[16:31], v[140:143], v[152:155], v[16:31]
  ds_read_b64_tr_b16 v[120:121], v139 offset:24576
  v_mfma_f32_32x32x16_bf16 v[32:47], v[140:143], v[156:159], v[32:47]
  ds_read_b64_tr_b16 v[122:123], v139 offset:25600
  v_mfma_f32_32x32x16_bf16 v[48:63], v[144:147], v[148:151], v[48:63]
  ds_read_b128 v[124:127], v162 offset:0
  v_mfma_f32_32x32x16_bf16 v[64:79], v[144:147], v[152:155], v[64:79]
  ds_read_b128 v[128:131], v162 offset:4096
  v_mfma_f32_32x32x16_bf16 v[80:95], v[144:147], v[156:159], v[80:95]
  ds_read_b128 v[132:135], v162 offset:8192
  v_add_u32 v162, 0x6000, v162
  s_waitcnt lgkmcnt(7)
  v_mfma_f32_32x32x16_bf16 v[0:15], v[96:99], v[104:107], v[0:15]
  ds_read_b64_tr_b16 v[140:141], v138 offset:28672
  ds_read_b64_tr_b16 v[142:143], v138 offset:29696
  v_mfma_f32_32x32x16_bf16 v[16:31], v[96:99], v[108:111], v[16:31]
  ds_read_b64_tr_b16 v[144:145], v139 offset:28672
  v_mfma_f32_32x32x16_bf16 v[32:47], v[96:99], v[112:115], v[32:47]
  ds_read_b64_tr_b16 v[146:147], v139 offset:29696
  v_mfma_f32_32x32x16_bf16 v[48:63], v[100:103], v[104:107], v[48:63]
  ds_read_b128 v[148:151], v163 offset:0
  v_mfma_f32_32x32x16_bf16 v[64:79], v[100:103], v[108:111], v[64:79]
  ds_read_b128 v[152:155], v163 offset:4096
  v_mfma_f32_32x32x16_bf16 v[80:95], v[100:103], v[112:115], v[80:95]
  ds_read_b128 v[156:159], v163 offset:8192
  v_add_u32 v163, 0x6000, v163
  s_waitcnt lgkmcnt(7)
  s_barrier
  v_mfma_f32_32x32x16_bf16 v[0:15], v[116:119], v[124:127], v[0:15]
  ds_read_b64_tr_b16 v[96:97], v138 offset:32768
  ds_read_b64_tr_b16 v[98:99], v138 offset:33792
  v_mfma_f32_32x32x16_bf16 v[16:31], v[116:119], v[128:131], v[16:31]
  ds_read_b64_tr_b16 v[100:101], v139 offset:32768
  v_mfma_f32_32x32x16_bf16 v[32:47], v[116:119], v[132:135], v[32:47]
  ds_read_b64_tr_b16 v[102:103], v139 offset:33792
  v_mfma_f32_32x32x16_bf16 v[48:63], v[120:123], v[124:127], v[48:63]
  ds_read_b128 v[104:107], v136 offset:0
  v_mfma_f32_32x32x16_bf16 v[64:79], v[120:123], v[128:131], v[64:79]
  ds_read_b128 v[108:111], v136 offset:4096
  v_mfma_f32_32x32x16_bf16 v[80:95], v[120:123], v[132:135], v[80:95]
  ds_read_b128 v[112:115], v136 offset:8192
  v_add_u32 v136, 0x6000, v136
  s_waitcnt lgkmcnt(7)
  v_mfma_f32_32x32x16_bf16 v[0:15], v[140:143], v[148:151], v[0:15]
  ds_read_b64_tr_b16 v[116:117], v138 offset:36864
  ds_read_b64_tr_b16 v[118:119], v138 offset:37888
  v_mfma_f32_32x32x16_bf16 v[16:31], v[140:143], v[152:155], v[16:31]
  ds_read_b64_tr_b16 v[120:121], v139 offset:36864
  v_mfma_f32_32x32x16_bf16 v[32:47], v[140:143], v[156:159], v[32:47]
  ds_read_b64_tr_b16 v[122:123], v139 offset:37888
  v_mfma_f32_32x32x16_bf16 v[48:63], v[144:147], v[148:151], v[48:63]
  ds_read_b128 v[124:127], v137 offset:0
  v_mfma_f32_32x32x16_bf16 v[64:79], v[144:147], v[152:155], v[64:79]
  ds_read_b128 v[128:131], v137 offset:4096
  v_mfma_f32_32x32x16_bf16 v[80:95], v[144:147], v[156:159], v[80:95]
  ds_read_b128 v[132:135], v137 offset:8192
  v_add_u32 v137, 0x6000, v137
  s_waitcnt lgkmcnt(7)
  v_mfma_f32_32x32x16_bf16 v[0:15], v[96:99], v[104:107], v[0:15]
  ds_read_b64_tr_b16 v[140:141], v138 offset:40960
  ds_read_b64_tr_b16 v[142:143], v138 offset:41984
  v_mfma_f32_32x32x16_bf16 v[16:31], v[96:99], v[108:111], v[16:31]
  ds_read_b64_tr_b16 v[144:145], v139 offset:40960
  v_mfma_f32_32x32x16_bf16 v[32:47], v[96:99], v[112:115], v[32:47]
  ds_read_b64_tr_b16 v[146:147], v139 offset:41984
  v_mfma_f32_32x32x16_bf16 v[48:63], v[100:103], v[104:107], v[48:63]
  ds_read_b128 v[148:151], v162 offset:0
  v_mfma_f32_32x32x16_bf16 v[64:79], v[100:103], v[108:111], v[64:79]
  ds_read_b128 v[152:155], v162 offset:4096
  v_mfma_f32_32x32x16_bf16 v[80:95], v[100:103], v[112:115], v[80:95]
  ds_read_b128 v[156:159], v162 offset:8192
  v_add_u32 v162, 0x6000, v162
  s_waitcnt lgkmcnt(7)
  v_mfma_f32_32x32x16_bf16 v[0:15], v[116:119], v[124:127], v[0:15]
  ds_read_b64_tr_b16 v[96:97], v138 offset:45056
  ds_read_b64_tr_b16 v[98:99], v138 offset:46080
  v_mfma_f32_32x32x16_bf16 v[16:31], v[116:119], v[128:131], v[16:31]
  ds_read_b64_tr_b16 v[100:101], v139 offset:45056
  v_mfma_f32_32x32x16_bf16 v[32:47], v[116:119], v[132:135], v[32:47]
  ds_read_b64_tr_b16 v[102:103], v139 offset:46080
  v_mfma_f32_32x32x16_bf16 v[48:63], v[120:123], v[124:127], v[48:63]
  ds_read_b128 v[104:107], v163 offset:0
  v_mfma_f32_32x32x16_bf16 v[64:79], v[120:123], v[128:131], v[64:79]
  ds_read_b128 v[108:111], v163 offset:4096
  v_mfma_f32_32x32x16_bf16 v[80:95], v[120:123], v[132:135], v[80:95]
  ds_read_b128 v[112:115], v163 offset:8192
  v_add_u32 v163, 0x6000, v163
  s_waitcnt lgkmcnt(7)
  s_barrier
  v_mfma_f32_32x32x16_bf16 v[0:15], v[140:143], v[148:151], v[0:15]
  ds_read_b64_tr_b16 v[116:117], v138 offset:49152
  ds_read_b64_tr_b16 v[118:119], v138 offset:50176
  v_mfma_f32_32x32x16_bf16 v[16:31], v[140:143], v[152:155], v[16:31]
  ds_read_b64_tr_b16 v[120:121], v139 offset:49152
  v_mfma_f32_32x32x16_bf16 v[32:47], v[140:143], v[156:159], v[32:47]
  ds_read_b64_tr_b16 v[122:123], v139 offset:50176
  v_mfma_f32_32x32x16_bf16 v[48:63], v[144:147], v[148:151], v[48:63]
  ds_read_b128 v[124:127], v136 offset:0
  v_mfma_f32_32x32x16_bf16 v[64:79], v[144:147], v[152:155], v[64:79]
  ds_read_b128 v[128:131], v136 offset:4096
  v_mfma_f32_32x32x16_bf16 v[80:95], v[144:147], v[156:159], v[80:95]
  ds_read_b128 v[132:135], v136 offset:8192
  v_add_u32 v136, 0xfffee000, v136
  s_waitcnt lgkmcnt(7)
  v_mfma_f32_32x32x16_bf16 v[0:15], v[96:99], v[104:107], v[0:15]
  ds_read_b64_tr_b16 v[140:141], v138 offset:53248
  ds_read_b64_tr_b16 v[142:143], v138 offset:54272
  v_mfma_f32_32x32x16_bf16 v[16:31], v[96:99], v[108:111], v[16:31]
  ds_read_b64_tr_b16 v[144:145], v139 offset:53248
  v_mfma_f32_32x32x16_bf16 v[32:47], v[96:99], v[112:115], v[32:47]
  ds_read_b64_tr_b16 v[146:147], v139 offset:54272
  v_mfma_f32_32x32x16_bf16 v[48:63], v[100:103], v[104:107], v[48:63]
  ds_read_b128 v[148:151], v137 offset:0
  v_mfma_f32_32x32x16_bf16 v[64:79], v[100:103], v[108:111], v[64:79]
  ds_read_b128 v[152:155], v137 offset:4096
  v_mfma_f32_32x32x16_bf16 v[80:95], v[100:103], v[112:115], v[80:95]
  ds_read_b128 v[156:159], v137 offset:8192
  v_add_u32 v137, 0xfffee000, v137
  s_waitcnt lgkmcnt(7)
  v_mfma_f32_32x32x16_bf16 v[0:15], v[116:119], v[124:127], v[0:15]
  ds_read_b64_tr_b16 v[96:97], v138 offset:57344
  ds_read_b64_tr_b16 v[98:99], v138 offset:58368
  v_mfma_f32_32x32x16_bf16 v[16:31], v[116:119], v[128:131], v[16:31]
  ds_read_b64_tr_b16 v[100:101], v139 offset:57344
  v_mfma_f32_32x32x16_bf16 v[32:47], v[116:119], v[132:135], v[32:47]
  ds_read_b64_tr_b16 v[102:103], v139 offset:58368
  v_mfma_f32_32x32x16_bf16 v[48:63], v[120:123], v[124:127], v[48:63]
  ds_read_b128 v[104:107], v162 offset:0
  v_mfma_f32_32x32x16_bf16 v[64:79], v[120:123], v[128:131], v[64:79]
  ds_read_b128 v[108:111], v162 offset:4096
  v_mfma_f32_32x32x16_bf16 v[80:95], v[120:123], v[132:135], v[80:95]
  ds_read_b128 v[112:115], v162 offset:8192
  v_add_u32 v162, 0xfffee000, v162
  s_waitcnt lgkmcnt(7)
  v_mfma_f32_32x32x16_bf16 v[0:15], v[140:143], v[148:151], v[0:15]
  ds_read_b64_tr_b16 v[116:117], v138 offset:61440
  ds_read_b64_tr_b16 v[118:119], v138 offset:62464
  v_mfma_f32_32x32x16_bf16 v[16:31], v[140:143], v[152:155], v[16:31]
  ds_read_b64_tr_b16 v[120:121], v139 offset:61440
  v_mfma_f32_32x32x16_bf16 v[32:47], v[140:143], v[156:159], v[32:47]
  ds_read_b64_tr_b16 v[122:123], v139 offset:62464
  v_mfma_f32_32x32x16_bf16 v[48:63], v[144:147], v[148:151], v[48:63]
  ds_read_b128 v[124:127], v163 offset:0
  v_mfma_f32_32x32x16_bf16 v[64:79], v[144:147], v[152:155], v[64:79]
  ds_read_b128 v[128:131], v163 offset:4096
  v_mfma_f32_32x32x16_bf16 v[80:95], v[144:147], v[156:159], v[80:95]
  ds_read_b128 v[132:135], v163 offset:8192
  v_add_u32 v163, 0xfffee000, v163
  s_waitcnt lgkmcnt(7)
  s_barrier
  v_mfma_f32_32x32x16_bf16 v[0:15], v[96:99], v[104:107], v[0:15]
  ds_read_b64_tr_b16 v[140:141], v138 offset:0
  ds_read_b64_tr_b16 v[142:143], v138 offset:1024
  v_mfma_f32_32x32x16_bf16 v[16:31], v[96:99], v[108:111], v[16:31]
  ds_read_b64_tr_b16 v[144:145], v139 offset:0
  v_mfma_f32_32x32x16_bf16 v[32:47], v[96:99], v[112:115], v[32:47]
  ds_read_b64_tr_b16 v[146:147], v139 offset:1024
  v_mfma_f32_32x32x16_bf16 v[48:63], v[100:103], v[104:107], v[48:63]
  ds_read_b128 v[148:151], v136 offset:0
  v_mfma_f32_32x32x16_bf16 v[64:79], v[100:103], v[108:111], v[64:79]
  ds_read_b128 v[152:155], v136 offset:4096
  v_mfma_f32_32x32x16_bf16 v[80:95], v[100:103], v[112:115], v[80:95]
  ds_read_b128 v[156:159], v136 offset:8192
  v_add_u32 v136, 0x6000, v136
  s_waitcnt lgkmcnt(7)
  v_mfma_f32_32x32x16_bf16 v[0:15], v[116:119], v[124:127], v[0:15]
  ds_read_b64_tr_b16 v[96:97], v138 offset:4096
  ds_read_b64_tr_b16 v[98:99], v138 offset:5120
  v_mfma_f32_32x32x16_bf16 v[16:31], v[116:119], v[128:131], v[16:31]
  ds_read_b64_tr_b16 v[100:101], v139 offset:4096
  v_mfma_f32_32x32x16_bf16 v[32:47], v[116:119], v[132:135], v[32:47]
  ds_read_b64_tr_b16 v[102:103], v139 offset:5120
  v_mfma_f32_32x32x16_bf16 v[48:63], v[120:123], v[124:127], v[48:63]
  ds_read_b128 v[104:107], v137 offset:0
  v_mfma_f32_32x32x16_bf16 v[64:79], v[120:123], v[128:131], v[64:79]
  ds_read_b128 v[108:111], v137 offset:4096
  v_mfma_f32_32x32x16_bf16 v[80:95], v[120:123], v[132:135], v[80:95]
  ds_read_b128 v[112:115], v137 offset:8192
  v_add_u32 v137, 0x6000, v137
  s_waitcnt lgkmcnt(7)
  v_mfma_f32_32x32x16_bf16 v[0:15], v[140:143], v[148:151], v[0:15]
  ds_read_b64_tr_b16 v[116:117], v138 offset:8192
  ds_read_b64_tr_b16 v[118:119], v138 offset:9216
  v_mfma_f32_32x32x16_bf16 v[16:31], v[140:143], v[152:155], v[16:31]
  ds_read_b64_tr_b16 v[120:121], v139 offset:8192
  v_mfma_f32_32x32x16_bf16 v[32:47], v[140:143], v[156:159], v[32:47]
  ds_read_b64_tr_b16 v[122:123], v139 offset:9216
  v_mfma_f32_32x32x16_bf16 v[48:63], v[144:147], v[148:151], v[48:63]
  ds_read_b128 v[124:127], v162 offset:0
  v_mfma_f32_32x32x16_bf16 v[64:79], v[144:147], v[152:155], v[64:79]
  ds_read_b128 v[128:131], v162 offset:4096
  v_mfma_f32_32x32x16_bf16 v[80:95], v[144:147], v[156:159], v[80:95]
  ds_read_b128 v[132:135], v162 offset:8192
  v_add_u32 v162, 0x6000, v162
  s_waitcnt lgkmcnt(7)
  v_mfma_f32_32x32x16_bf16 v[0:15], v[96:99], v[104:107], v[0:15]
  ds_read_b64_tr_b16 v[140:141], v138 offset:12288
  ds_read_b64_tr_b16 v[142:143], v138 offset:13312
  v_mfma_f32_32x32x16_bf16 v[16:31], v[96:99], v[108:111], v[16:31]
  ds_read_b64_tr_b16 v[144:145], v139 offset:12288
  v_mfma_f32_32x32x16_bf16 v[32:47], v[96:99], v[112:115], v[32:47]
  ds_read_b64_tr_b16 v[146:147], v139 offset:13312
  v_mfma_f32_32x32x16_bf16 v[48:63], v[100:103], v[104:107], v[48:63]
  ds_read_b128 v[148:151], v163 offset:0
  v_mfma_f32_32x32x16_bf16 v[64:79], v[100:103], v[108:111], v[64:79]
  ds_read_b128 v[152:155], v163 offset:4096
  v_mfma_f32_32x32x16_bf16 v[80:95], v[100:103], v[112:115], v[80:95]
  ds_read_b128 v[156:159], v163 offset:8192
  v_add_u32 v163, 0x6000, v163
  s_waitcnt lgkmcnt(7)
  v_mfma_f32_32x32x16_bf16 v[0:15], v[116:119], v[124:127], v[0:15]
  ds_read_b64_tr_b16 v[96:97], v138 offset:16384
  ds_read_b64_tr_b16 v[98:99], v138 offset:17408
  v_mfma_f32_32x32x16_bf16 v[16:31], v[116:119], v[128:131], v[16:31]
  ds_read_b64_tr_b16 v[100:101], v139 offset:16384
  v_mfma_f32_32x32x16_bf16 v[32:47], v[116:119], v[132:135], v[32:47]
  ds_read_b64_tr_b16 v[102:103], v139 offset:17408
  v_mfma_f32_32x32x16_bf16 v[48:63], v[120:123], v[124:127], v[48:63]
  ds_read_b128 v[104:107], v136 offset:0
  v_mfma_f32_32x32x16_bf16 v[64:79], v[120:123], v[128:131], v[64:79]
  ds_read_b128 v[108:111], v136 offset:4096
  v_mfma_f32_32x32x16_bf16 v[80:95], v[120:123], v[132:135], v[80:95]
  ds_read_b128 v[112:115], v136 offset:8192
  s_waitcnt lgkmcnt(7)
  v_mfma_f32_32x32x16_bf16 v[0:15], v[140:143], v[148:151], v[0:15]
  ds_read_b64_tr_b16 v[116:117], v138 offset:20480
  ds_read_b64_tr_b16 v[118:119], v138 offset:21504
  v_mfma_f32_32x32x16_bf16 v[16:31], v[140:143], v[152:155], v[16:31]
  ds_read_b64_tr_b16 v[120:121], v139 offset:20480
  v_mfma_f32_32x32x16_bf16 v[32:47], v[140:143], v[156:159], v[32:47]
  ds_read_b64_tr_b16 v[122:123], v139 offset:21504
  v_mfma_f32_32x32x16_bf16 v[48:63], v[144:147], v[148:151], v[48:63]
  ds_read_b128 v[124:127], v137 offset:0
  v_mfma_f32_32x32x16_bf16 v[64:79], v[144:147], v[152:155], v[64:79]
  ds_read_b128 v[128:131], v137 offset:4096
  v_mfma_f32_32x32x16_bf16 v[80:95], v[144:147], v[156:159], v[80:95]
  ds_read_b128 v[132:135], v137 offset:8192
  s_waitcnt lgkmcnt(7)
  v_mfma_f32_32x32x16_bf16 v[0:15], v[96:99], v[104:107], v[0:15]
  ds_read_b64_tr_b16 v[140:141], v138 offset:24576
  ds_read_b64_tr_b16 v[142:143], v138 offset:25600
  v_mfma_f32_32x32x16_bf16 v[16:31], v[96:99], v[108:111], v[16:31]
  ds_read_b64_tr_b16 v[144:145], v139 offset:24576
  v_mfma_f32_32x32x16_bf16 v[32:47], v[96:99], v[112:115], v[32:47]
  ds_read_b64_tr_b16 v[146:147], v139 offset:25600
  v_mfma_f32_32x32x16_bf16 v[48:63], v[100:103], v[104:107], v[48:63]
  ds_read_b128 v[148:151], v162 offset:0
  v_mfma_f32_32x32x16_bf16 v[64:79], v[100:103], v[108:111], v[64:79]
  ds_read_b128 v[152:155], v162 offset:4096
  v_mfma_f32_32x32x16_bf16 v[80:95], v[100:103], v[112:115], v[80:95]
  ds_read_b128 v[156:159], v162 offset:8192
  s_waitcnt lgkmcnt(7)
  v_mfma_f32_32x32x16_bf16 v[0:15], v[116:119], v[124:127], v[0:15]
  ds_read_b64_tr_b16 v[96:97], v138 offset:28672
  ds_read_b64_tr_b16 v[98:99], v138 offset:29696
  v_mfma_f32_32x32x16_bf16 v[16:31], v[116:119], v[128:131], v[16:31]
  ds_read_b64_tr_b16 v[100:101], v139 offset:28672
  v_mfma_f32_32x32x16_bf16 v[32:47], v[116:119], v[132:135], v[32:47]
  ds_read_b64_tr_b16 v[102:103], v139 offset:29696
  v_mfma_f32_32x32x16_bf16 v[48:63], v[120:123], v[124:127], v[48:63]
  ds_read_b128 v[104:107], v163 offset:0
  v_mfma_f32_32x32x16_bf16 v[64:79], v[120:123], v[128:131], v[64:79]
  ds_read_b128 v[108:111], v163 offset:4096
  v_mfma_f32_32x32x16_bf16 v[80:95], v[120:123], v[132:135], v[80:95]
  ds_read_b128 v[112:115], v163 offset:8192
  s_waitcnt lgkmcnt(7)
  v_mfma_f32_32x32x16_bf16 v[0:15], v[140:143], v[148:151], v[0:15]
  v_mfma_f32_32x32x16_bf16 v[16:31], v[140:143], v[152:155], v[16:31]
  v_mfma_f32_32x32x16_bf16 v[32:47], v[140:143], v[156:159], v[32:47]
  v_mfma_f32_32x32x16_bf16 v[48:63], v[144:147], v[148:151], v[48:63]
  v_mfma_f32_32x32x16_bf16 v[64:79], v[144:147], v[152:155], v[64:79]
  v_mfma_f32_32x32x16_bf16 v[80:95], v[144:147], v[156:159], v[80:95]
  s_waitcnt lgkmcnt(0)
  s_barrier
  v_mfma_f32_32x32x16_bf16 v[0:15], v[96:99], v[104:107], v[0:15]
  v_mfma_f32_32x32x16_bf16 v[16:31], v[96:99], v[108:111], v[16:31]
  v_mfma_f32_32x32x16_bf16 v[32:47], v[96:99], v[112:115], v[32:47]
  v_mfma_f32_32x32x16_bf16 v[48:63], v[100:103], v[104:107], v[48:63]
  v_mfma_f32_32x32x16_bf16 v[64:79], v[100:103], v[108:111], v[64:79]
  v_mfma_f32_32x32x16_bf16 v[80:95], v[100:103], v[112:115], v[80:95]
  s_nop 15
  s_lshl_b32 s55, s49, 12
  v_add_u32 v140, s55, v165
  s_cmp_eq_u32 s48, 0
  s_cbranch_scc0 K_cons_q1
  v_cvt_pk_bf16_f32 v96, v0, v1
  v_cvt_pk_bf16_f32 v97, v2, v3
  v_cvt_pk_bf16_f32 v98, v4, v5
  v_cvt_pk_bf16_f32 v99, v6, v7
  ds_write_b128 v140, v[96:99] offset:16384
  v_cvt_pk_bf16_f32 v100, v8, v9
  v_cvt_pk_bf16_f32 v101, v10, v11
  v_cvt_pk_bf16_f32 v102, v12, v13
  v_cvt_pk_bf16_f32 v103, v14, v15
  ds_write_b128 v140, v[100:103] offset:17408
  v_cvt_pk_bf16_f32 v104, v48, v49
  v_cvt_pk_bf16_f32 v105, v50, v51
  v_cvt_pk_bf16_f32 v106, v52, v53
  v_cvt_pk_bf16_f32 v107, v54, v55
  ds_write_b128 v140, v[104:107] offset:18432
  v_cvt_pk_bf16_f32 v108, v56, v57
  v_cvt_pk_bf16_f32 v109, v58, v59
  v_cvt_pk_bf16_f32 v110, v60, v61
  v_cvt_pk_bf16_f32 v111, v62, v63
  ds_write_b128 v140, v[108:111] offset:19456
  v_cvt_pk_bf16_f32 v112, v16, v17
  v_cvt_pk_bf16_f32 v113, v18, v19
  v_cvt_pk_bf16_f32 v114, v20, v21
  v_cvt_pk_bf16_f32 v115, v22, v23
  ds_write_b128 v140, v[112:115] offset:24576
  v_cvt_pk_bf16_f32 v116, v24, v25
  v_cvt_pk_bf16_f32 v117, v26, v27
  v_cvt_pk_bf16_f32 v118, v28, v29
  v_cvt_pk_bf16_f32 v119, v30, v31
  ds_write_b128 v140, v[116:119] offset:25600
  v_cvt_pk_bf16_f32 v120, v64, v65
  v_cvt_pk_bf16_f32 v121, v66, v67
  v_cvt_pk_bf16_f32 v122, v68, v69
  v_cvt_pk_bf16_f32 v123, v70, v71
  ds_write_b128 v140, v[120:123] offset:26624
  v_cvt_pk_bf16_f32 v124, v72, v73
  v_cvt_pk_bf16_f32 v125, v74, v75
  v_cvt_pk_bf16_f32 v126, v76, v77
  v_cvt_pk_bf16_f32 v127, v78, v79
  ds_write_b128 v140, v[124:127] offset:27648
  s_waitcnt lgkmcnt(4)
  v_cvt_pk_bf16_f32 v96, v32, v33
  v_cvt_pk_bf16_f32 v97, v34, v35
  v_cvt_pk_bf16_f32 v98, v36, v37
  v_cvt_pk_bf16_f32 v99, v38, v39
  ds_write_b128 v140, v[96:99] offset:32768
  v_cvt_pk_bf16_f32 v100, v40, v41
  v_cvt_pk_bf16_f32 v101, v42, v43
  v_cvt_pk_bf16_f32 v102, v44, v45
  v_cvt_pk_bf16_f32 v103, v46, v47
  ds_write_b128 v140, v[100:103] offset:33792
  v_cvt_pk_bf16_f32 v104, v80, v81
  v_cvt_pk_bf16_f32 v105, v82, v83
  v_cvt_pk_bf16_f32 v106, v84, v85
  v_cvt_pk_bf16_f32 v107, v86, v87
  ds_write_b128 v140, v[104:107] offset:34816
  v_cvt_pk_bf16_f32 v108, v88, v89
  v_cvt_pk_bf16_f32 v109, v90, v91
  v_cvt_pk_bf16_f32 v110, v92, v93
  v_cvt_pk_bf16_f32 v111, v94, v95
  ds_write_b128 v140, v[108:111] offset:35840
  s_branch K_qx
K_cons_q1:
  v_cvt_pk_bf16_f32 v96, v0, v1
  v_cvt_pk_bf16_f32 v97, v2, v3
  v_cvt_pk_bf16_f32 v98, v4, v5
  v_cvt_pk_bf16_f32 v99, v6, v7
  ds_write_b128 v140, v[96:99] offset:40960
  v_cvt_pk_bf16_f32 v100, v8, v9
  v_cvt_pk_bf16_f32 v101, v10, v11
  v_cvt_pk_bf16_f32 v102, v12, v13
  v_cvt_pk_bf16_f32 v103, v14, v15
  ds_write_b128 v140, v[100:103] offset:41984
  v_cvt_pk_bf16_f32 v104, v48, v49
  v_cvt_pk_bf16_f32 v105, v50, v51
  v_cvt_pk_bf16_f32 v106, v52, v53
  v_cvt_pk_bf16_f32 v107, v54, v55
  ds_write_b128 v140, v[104:107] offset:43008
  v_cvt_pk_bf16_f32 v108, v56, v57
  v_cvt_pk_bf16_f32 v109, v58, v59
  v_cvt_pk_bf16_f32 v110, v60, v61
  v_cvt_pk_bf16_f32 v111, v62, v63
  ds_write_b128 v140, v[108:111] offset:44032
  v_cvt_pk_bf16_f32 v112, v16, v17
  v_cvt_pk_bf16_f32 v113, v18, v19
  v_cvt_pk_bf16_f32 v114, v20, v21
  v_cvt_pk_bf16_f32 v115, v22, v23
  v_add_u32 v141, 114688, v140
  ds_write_b128 v141, v[112:115]
  v_cvt_pk_bf16_f32 v116, v24, v25
  v_cvt_pk_bf16_f32 v117, v26, v27
  v_cvt_pk_bf16_f32 v118, v28, v29
  v_cvt_pk_bf16_f32 v119, v30, v31
  v_add_u32 v141, 115712, v140
  ds_write_b128 v141, v[116:119]
  v_cvt_pk_bf16_f32 v120, v64, v65
  v_cvt_pk_bf16_f32 v121, v66, v67
  v_cvt_pk_bf16_f32 v122, v68, v69
  v_cvt_pk_bf16_f32 v123, v70, v71
  v_add_u32 v141, 116736, v140
  ds_write_b128 v141, v[120:123]
  v_cvt_pk_bf16_f32 v124, v72, v73
  v_cvt_pk_bf16_f32 v125, v74, v75
  v_cvt_pk_bf16_f32 v126, v76, v77
  v_cvt_pk_bf16_f32 v127, v78, v79
  v_add_u32 v141, 117760, v140
  ds_write_b128 v141, v[124:127]
  s_waitcnt lgkmcnt(4)
  v_cvt_pk_bf16_f32 v96, v32, v33
  v_cvt_pk_bf16_f32 v97, v34, v35
  v_cvt_pk_bf16_f32 v98, v36, v37
  v_cvt_pk_bf16_f32 v99, v38, v39
  v_add_u32 v141, 122880, v140
  ds_write_b128 v141, v[96:99]
  v_cvt_pk_bf16_f32 v100, v40, v41
  v_cvt_pk_bf16_f32 v101, v42, v43
  v_cvt_pk_bf16_f32 v102, v44, v45
  v_cvt_pk_bf16_f32 v103, v46, v47
  v_add_u32 v141, 123904, v140
  ds_write_b128 v141, v[100:103]
  v_cvt_pk_bf16_f32 v104, v80, v81
  v_cvt_pk_bf16_f32 v105, v82, v83
  v_cvt_pk_bf16_f32 v106, v84, v85
  v_cvt_pk_bf16_f32 v107, v86, v87
  v_add_u32 v141, 124928, v140
  ds_write_b128 v141, v[104:107]
  v_cvt_pk_bf16_f32 v108, v88, v89
  v_cvt_pk_bf16_f32 v109, v90, v91
  v_cvt_pk_bf16_f32 v110, v92, v93
  v_cvt_pk_bf16_f32 v111, v94, v95
  v_add_u32 v141, 125952, v140
  ds_write_b128 v141, v[108:111]
K_qx:
  s_waitcnt lgkmcnt(0)
  s_barrier
  s_lshl_b32 s55, s48, 13
  s_add_u32 s55, s55, 16384
  s_add_u32 s56, s55, 65536
  s_cmp_lt_u32 s48, 4
  s_cselect_b32 s55, s55, s56
  v_add_u32 v162, s55, v165
  ds_read_b128 v[64:67], v162 offset:0
  ds_read_b128 v[68:71], v162 offset:1024
  ds_read_b128 v[72:75], v162 offset:2048
  ds_read_b128 v[76:79], v162 offset:3072
  ds_read_b128 v[80:83], v162 offset:4096
  ds_read_b128 v[84:87], v162 offset:5120
  ds_read_b128 v[88:91], v162 offset:6144
  ds_read_b128 v[92:95], v162 offset:7168
  ds_read_b128 v[136:139], v160
  v_xor_b32 v163, 32, v160
  ds_read_b128 v[140:143], v163
  v_xor_b32 v162, 64, v160
  ds_read_b128 v[144:147], v162
  v_xor_b32 v163, 96, v160
  ds_read_b128 v[148:151], v163
  s_waitcnt lgkmcnt(3)
  v_mfma_f32_32x32x16_bf16 v[96:111], v[136:139], v[64:67], 0
  v_xor_b32 v162, 128, v160
  ds_read_b128 v[136:139], v162
  s_waitcnt lgkmcnt(3)
  v_mfma_f32_32x32x16_bf16 v[96:111], v[140:143], v[68:71], v[96:111]
  v_xor_b32 v163, 160, v160
  ds_read_b128 v[140:143], v163
  s_cmp_lt_u32 s36, 8
  s_cbranch_scc1 K_dk0
  s_add_u32 s53, s3, 1
  s_and_b32 s53, s53, 7
  s_lshl_b32 s53, s53, 14
  s_add_u32 s53, s53, s39
  s_add_u32 s54, s47, 147456
  s_mov_b32 m0, s54
  s_nop 0
  buffer_load_dwordx4 v167, s[24:27], s53 offen nt lds
  s_add_u32 s53, s3, 3
  s_and_b32 s53, s53, 7
  s_lshl_b32 s53, s53, 14
  s_add_u32 s53, s53, s39
  s_add_u32 s54, s47, 0
  s_mov_b32 m0, s54
  s_nop 0
  buffer_load_dwordx4 v166, s[20:23], s53 offen nt lds
K_dk0:
  s_waitcnt lgkmcnt(3)
  v_mfma_f32_32x32x16_bf16 v[96:111], v[144:147], v[72:75], v[96:111]
  v_xor_b32 v162, 192, v160
  ds_read_b128 v[144:147], v162
  s_waitcnt lgkmcnt(3)
  v_mfma_f32_32x32x16_bf16 v[96:111], v[148:151], v[76:79], v[96:111]
  v_xor_b32 v163, 224, v160
  ds_read_b128 v[148:151], v163
  s_cmp_lt_u32 s36, 8
  s_cbranch_scc1 K_dk1
  s_add_u32 s53, s3, 1
  s_and_b32 s53, s53, 7
  s_lshl_b32 s53, s53, 14
  s_add_u32 s53, s53, s39
  s_add_u32 s53, s53, 4096
  s_add_u32 s54, s47, 151552
  s_mov_b32 m0, s54
  s_nop 0
  buffer_load_dwordx4 v167, s[24:27], s53 offen nt lds
  s_add_u32 s53, s3, 3
  s_and_b32 s53, s53, 7
  s_lshl_b32 s53, s53, 14
  s_add_u32 s53, s53, s39
  s_add_u32 s53, s53, 4096
  s_add_u32 s54, s47, 4096
  s_mov_b32 m0, s54
  s_nop 0
  buffer_load_dwordx4 v166, s[20:23], s53 offen nt lds
K_dk1:
  s_waitcnt lgkmcnt(3)
  v_mfma_f32_32x32x16_bf16 v[96:111], v[136:139], v[80:83], v[96:111]
  v_add_u32 v160, 0x14000, v160
  ds_read_b128 v[136:139], v160
  s_waitcnt lgkmcnt(3)
  v_mfma_f32_32x32x16_bf16 v[96:111], v[140:143], v[84:87], v[96:111]
  v_xor_b32 v163, 32, v160
  ds_read_b128 v[140:143], v163
  s_cmp_lt_u32 s36, 8
  s_cbranch_scc1 K_dk2
  s_add_u32 s53, s3, 1
  s_and_b32 s53, s53, 7
  s_lshl_b32 s53, s53, 14
  s_add_u32 s53, s53, s39
  s_add_u32 s53, s53, 8192
  s_add_u32 s54, s47, 155648
  s_mov_b32 m0, s54
  s_nop 0
  buffer_load_dwordx4 v167, s[24:27], s53 offen nt lds
  s_add_u32 s53, s3, 3
  s_and_b32 s53, s53, 7
  s_lshl_b32 s53, s53, 14
  s_add_u32 s53, s53, s39
  s_add_u32 s53, s53, 8192
  s_add_u32 s54, s47, 8192
  s_mov_b32 m0, s54
  s_nop 0
  buffer_load_dwordx4 v166, s[20:23], s53 offen nt lds
K_dk2:
  s_waitcnt lgkmcnt(3)
  v_mfma_f32_32x32x16_bf16 v[96:111], v[144:147], v[88:91], v[96:111]
  v_xor_b32 v162, 64, v160
  ds_read_b128 v[144:147], v162
  s_waitcnt lgkmcnt(3)
  v_mfma_f32_32x32x16_bf16 v[96:111], v[148:151], v[92:95], v[96:111]
  v_xor_b32 v163, 96, v160
  ds_read_b128 v[148:151], v163
  s_cmp_lt_u32 s36, 8
  s_cbranch_scc1 K_dk3
  s_add_u32 s53, s3, 1
  s_and_b32 s53, s53, 7
  s_lshl_b32 s53, s53, 14
  s_add_u32 s53, s53, s39
  s_add_u32 s53, s53, 12288
  s_add_u32 s54, s47, 159744
  s_mov_b32 m0, s54
  s_nop 0
  buffer_load_dwordx4 v167, s[24:27], s53 offen nt lds
  s_add_u32 s53, s3, 3
  s_and_b32 s53, s53, 7
  s_lshl_b32 s53, s53, 14
  s_add_u32 s53, s53, s39
  s_add_u32 s53, s53, 12288
  s_add_u32 s54, s47, 12288
  s_mov_b32 m0, s54
  s_nop 0
  buffer_load_dwordx4 v166, s[20:23], s53 offen nt lds
K_dk3:
  s_nop 9
  v_max3_f32 v154, v96, v97, v98
  v_max3_f32 v155, v99, v100, v101
  v_max3_f32 v154, v154, v102, v103
  v_max3_f32 v155, v155, v104, v105
  v_max3_f32 v154, v154, v106, v107
  v_max3_f32 v155, v155, v108, v109
  v_max3_f32 v154, v154, v110, v111
  v_max_f32 v154, v154, v155
  v_mov_b32 v155, v154
  s_nop 1
  v_permlane32_swap_b32 v154, v155
  s_nop 1
  v_max_f32 v154, v154, v155
  v_mul_f32 v164, s44, v154
  v_mov_b32 v165, 0
  v_fma_f32 v96, v96, s44, -v164
  v_fma_f32 v97, v97, s44, -v164
  v_fma_f32 v98, v98, s44, -v164
  v_fma_f32 v99, v99, s44, -v164
  v_fma_f32 v100, v100, s44, -v164
  v_fma_f32 v101, v101, s44, -v164
  v_fma_f32 v102, v102, s44, -v164
  v_fma_f32 v103, v103, s44, -v164
  v_fma_f32 v104, v104, s44, -v164
  v_fma_f32 v105, v105, s44, -v164
  v_fma_f32 v106, v106, s44, -v164
  v_fma_f32 v107, v107, s44, -v164
  v_fma_f32 v108, v108, s44, -v164
  v_fma_f32 v109, v109, s44, -v164
  v_fma_f32 v110, v110, s44, -v164
  v_fma_f32 v111, v111, s44, -v164
  v_exp_f32 v152, v96
  v_exp_f32 v153, v97
  v_mov_b32 v158, v152
  v_cvt_pk_bf16_f32 v128, v152, v153
  v_mov_b32 v159, v153
  v_exp_f32 v154, v98
  v_exp_f32 v155, v99
  v_add_f32 v158, v158, v154
  v_cvt_pk_bf16_f32 v129, v154, v155
  v_add_f32 v159, v159, v155
  v_exp_f32 v156, v100
  v_exp_f32 v157, v101
  v_add_f32 v158, v158, v156
  v_cvt_pk_bf16_f32 v130, v156, v157
  v_add_f32 v159, v159, v157
  v_exp_f32 v152, v102
  v_exp_f32 v153, v103
  v_add_f32 v158, v158, v152
  v_cvt_pk_bf16_f32 v131, v152, v153
  v_add_f32 v159, v159, v153
  s_cmp_lt_u32 s36, 8
  s_cbranch_scc1 K_wk0
  s_waitcnt vmcnt(8)
K_wk0:
  s_barrier
  s_setprio 3
  s_waitcnt lgkmcnt(3)
  v_mfma_f32_32x32x16_bf16 v[112:127], v[136:139], v[64:67], 0
  v_xor_b32 v162, 128, v160
  ds_read_b128 v[136:139], v162
  v_exp_f32 v154, v104
  v_exp_f32 v155, v105
  s_waitcnt lgkmcnt(3)
  v_mfma_f32_32x32x16_bf16 v[112:127], v[140:143], v[68:71], v[112:127]
  v_xor_b32 v163, 160, v160
  ds_read_b128 v[140:143], v163
  v_add_f32 v158, v158, v154
  v_cvt_pk_bf16_f32 v132, v154, v155
  v_add_f32 v159, v159, v155
  s_cmp_lt_u32 s36, 8
  s_cbranch_scc1 K_dk4
  s_add_u32 s53, s3, 2
  s_and_b32 s53, s53, 7
  s_lshl_b32 s53, s53, 14
  s_add_u32 s53, s53, s39
  s_add_u32 s54, s47, 98304
  s_mov_b32 m0, s54
  s_nop 0
  buffer_load_dwordx4 v167, s[24:27], s53 offen nt lds
  s_add_u32 s53, s3, 2
  s_and_b32 s53, s53, 7
  s_lshl_b32 s53, s53, 14
  s_add_u32 s53, s53, s39
  s_add_u32 s53, s53, 4096
  s_add_u32 s54, s47, 102400
  s_mov_b32 m0, s54
  s_nop 0
  buffer_load_dwordx4 v167, s[24:27], s53 offen nt lds
  s_add_u32 s53, s3, 2
  s_and_b32 s53, s53, 7
  s_lshl_b32 s53, s53, 14
  s_add_u32 s53, s53, s39
  s_add_u32 s53, s53, 8192
  s_add_u32 s54, s47, 106496
  s_mov_b32 m0, s54
  s_nop 0
  buffer_load_dwordx4 v167, s[24:27], s53 offen nt lds
  s_add_u32 s53, s3, 2
  s_and_b32 s53, s53, 7
  s_lshl_b32 s53, s53, 14
  s_add_u32 s53, s53, s39
  s_add_u32 s53, s53, 12288
  s_add_u32 s54, s47, 110592
  s_mov_b32 m0, s54
  s_nop 0
  buffer_load_dwordx4 v167, s[24:27], s53 offen nt lds
  s_branch K_dd4
K_dk4:
  s_add_u32 s53, s3, 4
  s_and_b32 s53, s53, 7
  s_lshl_b32 s53, s53, 14
  s_add_u32 s53, s53, s39
  s_add_u32 s54, s47, 16384
  s_mov_b32 m0, s54
  s_nop 0
  buffer_load_dwordx4 v166, s[20:23], s53 offen nt lds
  s_add_u32 s53, s3, 4
  s_and_b32 s53, s53, 7
  s_lshl_b32 s53, s53, 14
  s_add_u32 s53, s53, s39
  s_add_u32 s53, s53, 8192
  s_add_u32 s54, s47, 24576
  s_mov_b32 m0, s54
  s_nop 0
  buffer_load_dwordx4 v166, s[20:23], s53 offen nt lds
K_dd4:
  s_waitcnt lgkmcnt(3)
  v_mfma_f32_32x32x16_bf16 v[112:127], v[144:147], v[72:75], v[112:127]
  v_xor_b32 v162, 192, v160
  ds_read_b128 v[144:147], v162
  v_exp_f32 v156, v106
  v_exp_f32 v157, v107
  s_waitcnt lgkmcnt(3)
  v_mfma_f32_32x32x16_bf16 v[112:127], v[148:151], v[76:79], v[112:127]
  v_xor_b32 v163, 224, v160
  ds_read_b128 v[148:151], v163
  v_add_f32 v158, v158, v156
  v_cvt_pk_bf16_f32 v133, v156, v157
  v_add_f32 v159, v159, v157
  s_setprio 2
  s_waitcnt lgkmcnt(3)
  v_mfma_f32_32x32x16_bf16 v[112:127], v[136:139], v[80:83], v[112:127]
  ds_read_b64_tr_b16 v[136:137], v161 offset:0
  ds_read_b64_tr_b16 v[138:139], v161 offset:2048
  v_exp_f32 v152, v108
  v_exp_f32 v153, v109
  s_waitcnt lgkmcnt(4)
  v_mfma_f32_32x32x16_bf16 v[112:127], v[140:143], v[84:87], v[112:127]
  v_xor_b32 v163, 64, v161
  ds_read_b64_tr_b16 v[140:141], v163 offset:0
  ds_read_b64_tr_b16 v[142:143], v163 offset:2048
  v_add_f32 v158, v158, v152
  v_cvt_pk_bf16_f32 v134, v152, v153
  v_add_f32 v159, v159, v153
  s_waitcnt lgkmcnt(5)
  v_mfma_f32_32x32x16_bf16 v[112:127], v[144:147], v[88:91], v[112:127]
  v_xor_b32 v162, 128, v161
  ds_read_b64_tr_b16 v[144:145], v162 offset:0
  ds_read_b64_tr_b16 v[146:147], v162 offset:2048
  v_exp_f32 v154, v110
  v_exp_f32 v155, v111
  s_waitcnt lgkmcnt(6)
  v_mfma_f32_32x32x16_bf16 v[112:127], v[148:151], v[92:95], v[112:127]
  v_xor_b32 v163, 192, v161
  ds_read_b64_tr_b16 v[148:149], v163 offset:0
  ds_read_b64_tr_b16 v[150:151], v163 offset:2048
  v_add_f32 v158, v158, v154
  v_cvt_pk_bf16_f32 v135, v154, v155
  v_add_f32 v159, v159, v155
  v_add_f32 v158, v158, v159
  v_add_f32 v165, v165, v158
  s_setprio 1
  s_waitcnt lgkmcnt(6)
  v_mfma_f32_32x32x16_bf16 v[0:15], v[136:139], v[128:131], 0
  ds_read_b64_tr_b16 v[136:137], v161 offset:4096
  ds_read_b64_tr_b16 v[138:139], v161 offset:6144
  s_waitcnt lgkmcnt(6)
  v_mfma_f32_32x32x16_bf16 v[16:31], v[140:143], v[128:131], 0
  v_xor_b32 v163, 64, v161
  ds_read_b64_tr_b16 v[140:141], v163 offset:4096
  ds_read_b64_tr_b16 v[142:143], v163 offset:6144
  s_waitcnt lgkmcnt(6)
  v_mfma_f32_32x32x16_bf16 v[32:47], v[144:147], v[128:131], 0
  v_xor_b32 v162, 128, v161
  ds_read_b64_tr_b16 v[144:145], v162 offset:4096
  ds_read_b64_tr_b16 v[146:147], v162 offset:6144
  v_fma_f32 v112, v112, s44, -v164
  v_fma_f32 v113, v113, s44, -v164
  v_fma_f32 v114, v114, s44, -v164
  v_fma_f32 v115, v115, s44, -v164
  v_fma_f32 v116, v116, s44, -v164
  v_fma_f32 v117, v117, s44, -v164
  v_fma_f32 v118, v118, s44, -v164
  v_fma_f32 v119, v119, s44, -v164
  s_waitcnt lgkmcnt(6)
  v_mfma_f32_32x32x16_bf16 v[48:63], v[148:151], v[128:131], 0
  v_xor_b32 v163, 192, v161
  ds_read_b64_tr_b16 v[148:149], v163 offset:4096
  ds_read_b64_tr_b16 v[150:151], v163 offset:6144
  v_fma_f32 v120, v120, s44, -v164
  v_fma_f32 v121, v121, s44, -v164
  v_fma_f32 v122, v122, s44, -v164
  v_fma_f32 v123, v123, s44, -v164
  v_fma_f32 v124, v124, s44, -v164
  v_fma_f32 v125, v125, s44, -v164
  v_fma_f32 v126, v126, s44, -v164
  v_fma_f32 v127, v127, s44, -v164
  s_setprio 0
  s_waitcnt lgkmcnt(6)
  v_mfma_f32_32x32x16_bf16 v[0:15], v[136:139], v[132:135], v[0:15]
  v_add_u32 v160, 0xffff4000, v160
  ds_read_b128 v[136:139], v160
  v_exp_f32 v152, v112
  v_exp_f32 v153, v113
  v_mov_b32 v158, v152
  v_cvt_pk_bf16_f32 v128, v152, v153
  v_mov_b32 v159, v153
  s_waitcnt lgkmcnt(5)
  v_mfma_f32_32x32x16_bf16 v[16:31], v[140:143], v[132:135], v[16:31]
  v_xor_b32 v163, 32, v160
  ds_read_b128 v[140:143], v163
  v_exp_f32 v154, v114
  v_exp_f32 v155, v115
  v_add_f32 v158, v158, v154
  v_cvt_pk_bf16_f32 v129, v154, v155
  v_add_f32 v159, v159, v155
  s_waitcnt lgkmcnt(4)
  v_mfma_f32_32x32x16_bf16 v[32:47], v[144:147], v[132:135], v[32:47]
  v_xor_b32 v162, 64, v160
  ds_read_b128 v[144:147], v162
  v_exp_f32 v156, v116
  v_exp_f32 v157, v117
  v_add_f32 v158, v158, v156
  v_cvt_pk_bf16_f32 v130, v156, v157
  v_add_f32 v159, v159, v157
  s_waitcnt lgkmcnt(3)
  v_mfma_f32_32x32x16_bf16 v[48:63], v[148:151], v[132:135], v[48:63]
  v_xor_b32 v163, 96, v160
  ds_read_b128 v[148:151], v163
  v_exp_f32 v152, v118
  v_exp_f32 v153, v119
  v_add_f32 v158, v158, v152
  v_cvt_pk_bf16_f32 v131, v152, v153
  v_add_f32 v159, v159, v153
  s_cmp_lt_u32 s36, 8
  s_cbranch_scc1 K_wk1
  s_waitcnt vmcnt(4)
K_wk1:
  s_barrier
  s_setprio 3
  s_waitcnt lgkmcnt(3)
  v_mfma_f32_32x32x16_bf16 v[96:111], v[136:139], v[64:67], 0
  v_xor_b32 v162, 128, v160
  ds_read_b128 v[136:139], v162
  v_exp_f32 v154, v120
  v_exp_f32 v155, v121
  s_waitcnt lgkmcnt(3)
  v_mfma_f32_32x32x16_bf16 v[96:111], v[140:143], v[68:71], v[96:111]
  v_xor_b32 v163, 160, v160
  ds_read_b128 v[140:143], v163
  v_add_f32 v158, v158, v154
  v_cvt_pk_bf16_f32 v132, v154, v155
  v_add_f32 v159, v159, v155
  s_cmp_lt_u32 s36, 8
  s_cbranch_scc1 K_dk5
  s_add_u32 s53, s3, 3
  s_and_b32 s53, s53, 7
  s_lshl_b32 s53, s53, 14
  s_add_u32 s53, s53, s39
  s_add_u32 s54, s47, 32768
  s_mov_b32 m0, s54
  s_nop 0
  buffer_load_dwordx4 v167, s[24:27], s53 offen nt lds
  s_add_u32 s53, s3, 3
  s_and_b32 s53, s53, 7
  s_lshl_b32 s53, s53, 14
  s_add_u32 s53, s53, s39
  s_add_u32 s53, s53, 4096
  s_add_u32 s54, s47, 36864
  s_mov_b32 m0, s54
  s_nop 0
  buffer_load_dwordx4 v167, s[24:27], s53 offen nt lds
  s_add_u32 s53, s3, 3
  s_and_b32 s53, s53, 7
  s_lshl_b32 s53, s53, 14
  s_add_u32 s53, s53, s39
  s_add_u32 s53, s53, 8192
  s_add_u32 s54, s47, 40960
  s_mov_b32 m0, s54
  s_nop 0
  buffer_load_dwordx4 v167, s[24:27], s53 offen nt lds
  s_add_u32 s53, s3, 3
  s_and_b32 s53, s53, 7
  s_lshl_b32 s53, s53, 14
  s_add_u32 s53, s53, s39
  s_add_u32 s53, s53, 12288
  s_add_u32 s54, s47, 45056
  s_mov_b32 m0, s54
  s_nop 0
  buffer_load_dwordx4 v167, s[24:27], s53 offen nt lds
  s_branch K_dd5
K_dk5:
  s_add_u32 s53, s3, 5
  s_and_b32 s53, s53, 7
  s_lshl_b32 s53, s53, 14
  s_add_u32 s53, s53, s39
  s_add_u32 s54, s47, 114688
  s_mov_b32 m0, s54
  s_nop 0
  buffer_load_dwordx4 v166, s[20:23], s53 offen nt lds
  s_add_u32 s53, s3, 5
  s_and_b32 s53, s53, 7
  s_lshl_b32 s53, s53, 14
  s_add_u32 s53, s53, s39
  s_add_u32 s53, s53, 8192
  s_add_u32 s54, s47, 122880
  s_mov_b32 m0, s54
  s_nop 0
  buffer_load_dwordx4 v166, s[20:23], s53 offen nt lds
K_dd5:
  s_waitcnt lgkmcnt(3)
  v_mfma_f32_32x32x16_bf16 v[96:111], v[144:147], v[72:75], v[96:111]
  v_xor_b32 v162, 192, v160
  ds_read_b128 v[144:147], v162
  v_exp_f32 v156, v122
  v_exp_f32 v157, v123
  s_waitcnt lgkmcnt(3)
  v_mfma_f32_32x32x16_bf16 v[96:111], v[148:151], v[76:79], v[96:111]
  v_xor_b32 v163, 224, v160
  ds_read_b128 v[148:151], v163
  v_add_f32 v158, v158, v156
  v_cvt_pk_bf16_f32 v133, v156, v157
  v_add_f32 v159, v159, v157
  s_setprio 2
  s_waitcnt lgkmcnt(3)
  v_mfma_f32_32x32x16_bf16 v[96:111], v[136:139], v[80:83], v[96:111]
  v_add_u32 v161, 0x14000, v161
  ds_read_b64_tr_b16 v[136:137], v161 offset:0
  ds_read_b64_tr_b16 v[138:139], v161 offset:2048
  v_exp_f32 v152, v124
  v_exp_f32 v153, v125
  s_waitcnt lgkmcnt(4)
  v_mfma_f32_32x32x16_bf16 v[96:111], v[140:143], v[84:87], v[96:111]
  v_xor_b32 v163, 64, v161
  ds_read_b64_tr_b16 v[140:141], v163 offset:0
  ds_read_b64_tr_b16 v[142:143], v163 offset:2048
  v_add_f32 v158, v158, v152
  v_cvt_pk_bf16_f32 v134, v152, v153
  v_add_f32 v159, v159, v153
  s_waitcnt lgkmcnt(5)
  v_mfma_f32_32x32x16_bf16 v[96:111], v[144:147], v[88:91], v[96:111]
  v_xor_b32 v162, 128, v161
  ds_read_b64_tr_b16 v[144:145], v162 offset:0
  ds_read_b64_tr_b16 v[146:147], v162 offset:2048
  v_exp_f32 v154, v126
  v_exp_f32 v155, v127
  s_waitcnt lgkmcnt(6)
  v_mfma_f32_32x32x16_bf16 v[96:111], v[148:151], v[92:95], v[96:111]
  v_xor_b32 v163, 192, v161
  ds_read_b64_tr_b16 v[148:149], v163 offset:0
  ds_read_b64_tr_b16 v[150:151], v163 offset:2048
  v_add_f32 v158, v158, v154
  v_cvt_pk_bf16_f32 v135, v154, v155
  v_add_f32 v159, v159, v155
  v_add_f32 v158, v158, v159
  v_cmp_nge_f32 vcc, 0x45800000, v158
  s_cbranch_vccnz K_rare1
K_back1:
  v_add_f32 v165, v165, v158
  s_setprio 1
  s_waitcnt lgkmcnt(6)
  v_mfma_f32_32x32x16_bf16 v[0:15], v[136:139], v[128:131], v[0:15]
  ds_read_b64_tr_b16 v[136:137], v161 offset:4096
  ds_read_b64_tr_b16 v[138:139], v161 offset:6144
  s_waitcnt lgkmcnt(6)
  v_mfma_f32_32x32x16_bf16 v[16:31], v[140:143], v[128:131], v[16:31]
  v_xor_b32 v163, 64, v161
  ds_read_b64_tr_b16 v[140:141], v163 offset:4096
  ds_read_b64_tr_b16 v[142:143], v163 offset:6144
  s_waitcnt lgkmcnt(6)
  v_mfma_f32_32x32x16_bf16 v[32:47], v[144:147], v[128:131], v[32:47]
  v_xor_b32 v162, 128, v161
  ds_read_b64_tr_b16 v[144:145], v162 offset:4096
  ds_read_b64_tr_b16 v[146:147], v162 offset:6144
  v_fma_f32 v96, v96, s44, -v164
  v_fma_f32 v97, v97, s44, -v164
  v_fma_f32 v98, v98, s44, -v164
  v_fma_f32 v99, v99, s44, -v164
  v_fma_f32 v100, v100, s44, -v164
  v_fma_f32 v101, v101, s44, -v164
  v_fma_f32 v102, v102, s44, -v164
  v_fma_f32 v103, v103, s44, -v164
  s_waitcnt lgkmcnt(6)
  v_mfma_f32_32x32x16_bf16 v[48:63], v[148:151], v[128:131], v[48:63]
  v_xor_b32 v163, 192, v161
  ds_read_b64_tr_b16 v[148:149], v163 offset:4096
  ds_read_b64_tr_b16 v[150:151], v163 offset:6144
  v_fma_f32 v104, v104, s44, -v164
  v_fma_f32 v105, v105, s44, -v164
  v_fma_f32 v106, v106, s44, -v164
  v_fma_f32 v107, v107, s44, -v164
  v_fma_f32 v108, v108, s44, -v164
  v_fma_f32 v109, v109, s44, -v164
  v_fma_f32 v110, v110, s44, -v164
  v_fma_f32 v111, v111, s44, -v164
  s_setprio 0
  s_waitcnt lgkmcnt(6)
  v_mfma_f32_32x32x16_bf16 v[0:15], v[136:139], v[132:135], v[0:15]
  v_add_u32 v160, 0xfffec000, v160
  ds_read_b128 v[136:139], v160
  v_exp_f32 v152, v96
  v_exp_f32 v153, v97
  v_mov_b32 v158, v152
  v_cvt_pk_bf16_f32 v128, v152, v153
  v_mov_b32 v159, v153
  s_waitcnt lgkmcnt(5)
  v_mfma_f32_32x32x16_bf16 v[16:31], v[140:143], v[132:135], v[16:31]
  v_xor_b32 v163, 32, v160
  ds_read_b128 v[140:143], v163
  v_exp_f32 v154, v98
  v_exp_f32 v155, v99
  v_add_f32 v158, v158, v154
  v_cvt_pk_bf16_f32 v129, v154, v155
  v_add_f32 v159, v159, v155
  s_waitcnt lgkmcnt(4)
  v_mfma_f32_32x32x16_bf16 v[32:47], v[144:147], v[132:135], v[32:47]
  v_xor_b32 v162, 64, v160
  ds_read_b128 v[144:147], v162
  v_exp_f32 v156, v100
  v_exp_f32 v157, v101
  v_add_f32 v158, v158, v156
  v_cvt_pk_bf16_f32 v130, v156, v157
  v_add_f32 v159, v159, v157
  s_waitcnt lgkmcnt(3)
  v_mfma_f32_32x32x16_bf16 v[48:63], v[148:151], v[132:135], v[48:63]
  v_xor_b32 v163, 96, v160
  ds_read_b128 v[148:151], v163
  v_exp_f32 v152, v102
  v_exp_f32 v153, v103
  v_add_f32 v158, v158, v152
  v_cvt_pk_bf16_f32 v131, v152, v153
  v_add_f32 v159, v159, v153
  s_cmp_lt_u32 s36, 8
  s_cbranch_scc1 K_wk2
  s_waitcnt vmcnt(4)
  s_branch K_go2
K_wk2:
  s_waitcnt vmcnt(2)
K_go2:
  s_barrier
  s_setprio 3
  s_waitcnt lgkmcnt(3)
  v_mfma_f32_32x32x16_bf16 v[112:127], v[136:139], v[64:67], 0
  v_xor_b32 v162, 128, v160
  ds_read_b128 v[136:139], v162
  v_exp_f32 v154, v104
  v_exp_f32 v155, v105
  s_waitcnt lgkmcnt(3)
  v_mfma_f32_32x32x16_bf16 v[112:127], v[140:143], v[68:71], v[112:127]
  v_xor_b32 v163, 160, v160
  ds_read_b128 v[140:143], v163
  v_add_f32 v158, v158, v154
  v_cvt_pk_bf16_f32 v132, v154, v155
  v_add_f32 v159, v159, v155
  s_cmp_lt_u32 s36, 8
  s_cbranch_scc1 K_dk6
  s_add_u32 s53, s3, 4
  s_and_b32 s53, s53, 7
  s_lshl_b32 s53, s53, 14
  s_add_u32 s53, s53, s39
  s_add_u32 s54, s47, 49152
  s_mov_b32 m0, s54
  s_nop 0
  buffer_load_dwordx4 v167, s[24:27], s53 offen nt lds
  s_add_u32 s53, s3, 4
  s_and_b32 s53, s53, 7
  s_lshl_b32 s53, s53, 14
  s_add_u32 s53, s53, s39
  s_add_u32 s53, s53, 4096
  s_add_u32 s54, s47, 53248
  s_mov_b32 m0, s54
  s_nop 0
  buffer_load_dwordx4 v167, s[24:27], s53 offen nt lds
  s_add_u32 s53, s3, 4
  s_and_b32 s53, s53, 7
  s_lshl_b32 s53, s53, 14
  s_add_u32 s53, s53, s39
  s_add_u32 s53, s53, 8192
  s_add_u32 s54, s47, 57344
  s_mov_b32 m0, s54
  s_nop 0
  buffer_load_dwordx4 v167, s[24:27], s53 offen nt lds
  s_add_u32 s53, s3, 4
  s_and_b32 s53, s53, 7
  s_lshl_b32 s53, s53, 14
  s_add_u32 s53, s53, s39
  s_add_u32 s53, s53, 12288
  s_add_u32 s54, s47, 61440
  s_mov_b32 m0, s54
  s_nop 0
  buffer_load_dwordx4 v167, s[24:27], s53 offen nt lds
  s_branch K_dd6
K_dk6:
  s_add_u32 s53, s3, 6
  s_and_b32 s53, s53, 7
  s_lshl_b32 s53, s53, 14
  s_add_u32 s53, s53, s39
  s_add_u32 s54, s47, 131072
  s_mov_b32 m0, s54
  s_nop 0
  buffer_load_dwordx4 v166, s[20:23], s53 offen nt lds
  s_add_u32 s53, s3, 6
  s_and_b32 s53, s53, 7
  s_lshl_b32 s53, s53, 14
  s_add_u32 s53, s53, s39
  s_add_u32 s53, s53, 8192
  s_add_u32 s54, s47, 139264
  s_mov_b32 m0, s54
  s_nop 0
  buffer_load_dwordx4 v166, s[20:23], s53 offen nt lds
K_dd6:
  s_waitcnt lgkmcnt(3)
  v_mfma_f32_32x32x16_bf16 v[112:127], v[144:147], v[72:75], v[112:127]
  v_xor_b32 v162, 192, v160
  ds_read_b128 v[144:147], v162
  v_exp_f32 v156, v106
  v_exp_f32 v157, v107
  s_waitcnt lgkmcnt(3)
  v_mfma_f32_32x32x16_bf16 v[112:127], v[148:151], v[76:79], v[112:127]
  v_xor_b32 v163, 224, v160
  ds_read_b128 v[148:151], v163
  v_add_f32 v158, v158, v156
  v_cvt_pk_bf16_f32 v133, v156, v157
  v_add_f32 v159, v159, v157
  s_setprio 2
  s_waitcnt lgkmcnt(3)
  v_mfma_f32_32x32x16_bf16 v[112:127], v[136:139], v[80:83], v[112:127]
  v_add_u32 v161, 0xffff4000, v161
  ds_read_b64_tr_b16 v[136:137], v161 offset:0
  ds_read_b64_tr_b16 v[138:139], v161 offset:2048
  v_exp_f32 v152, v108
  v_exp_f32 v153, v109
  s_waitcnt lgkmcnt(4)
  v_mfma_f32_32x32x16_bf16 v[112:127], v[140:143], v[84:87], v[112:127]
  v_xor_b32 v163, 64, v161
  ds_read_b64_tr_b16 v[140:141], v163 offset:0
  ds_read_b64_tr_b16 v[142:143], v163 offset:2048
  v_add_f32 v158, v158, v152
  v_cvt_pk_bf16_f32 v134, v152, v153
  v_add_f32 v159, v159, v153
  s_waitcnt lgkmcnt(5)
  v_mfma_f32_32x32x16_bf16 v[112:127], v[144:147], v[88:91], v[112:127]
  v_xor_b32 v162, 128, v161
  ds_read_b64_tr_b16 v[144:145], v162 offset:0
  ds_read_b64_tr_b16 v[146:147], v162 offset:2048
  v_exp_f32 v154, v110
  v_exp_f32 v155, v111
  s_waitcnt lgkmcnt(6)
  v_mfma_f32_32x32x16_bf16 v[112:127], v[148:151], v[92:95], v[112:127]
  v_xor_b32 v163, 192, v161
  ds_read_b64_tr_b16 v[148:149], v163 offset:0
  ds_read_b64_tr_b16 v[150:151], v163 offset:2048
  v_add_f32 v158, v158, v154
  v_cvt_pk_bf16_f32 v135, v154, v155
  v_add_f32 v159, v159, v155
  v_add_f32 v158, v158, v159
  v_cmp_nge_f32 vcc, 0x45800000, v158
  s_cbranch_vccnz K_rare2
K_back2:
  v_add_f32 v165, v165, v158
  s_setprio 1
  s_waitcnt lgkmcnt(6)
  v_mfma_f32_32x32x16_bf16 v[0:15], v[136:139], v[128:131], v[0:15]
  ds_read_b64_tr_b16 v[136:137], v161 offset:4096
  ds_read_b64_tr_b16 v[138:139], v161 offset:6144
  s_waitcnt lgkmcnt(6)
  v_mfma_f32_32x32x16_bf16 v[16:31], v[140:143], v[128:131], v[16:31]
  v_xor_b32 v163, 64, v161
  ds_read_b64_tr_b16 v[140:141], v163 offset:4096
  ds_read_b64_tr_b16 v[142:143], v163 offset:6144
  s_waitcnt lgkmcnt(6)
  v_mfma_f32_32x32x16_bf16 v[32:47], v[144:147], v[128:131], v[32:47]
  v_xor_b32 v162, 128, v161
  ds_read_b64_tr_b16 v[144:145], v162 offset:4096
  ds_read_b64_tr_b16 v[146:147], v162 offset:6144
  v_fma_f32 v112, v112, s44, -v164
  v_fma_f32 v113, v113, s44, -v164
  v_fma_f32 v114, v114, s44, -v164
  v_fma_f32 v115, v115, s44, -v164
  v_fma_f32 v116, v116, s44, -v164
  v_fma_f32 v117, v117, s44, -v164
  v_fma_f32 v118, v118, s44, -v164
  v_fma_f32 v119, v119, s44, -v164
  s_waitcnt lgkmcnt(6)
  v_mfma_f32_32x32x16_bf16 v[48:63], v[148:151], v[128:131], v[48:63]
  v_xor_b32 v163, 192, v161
  ds_read_b64_tr_b16 v[148:149], v163 offset:4096
  ds_read_b64_tr_b16 v[150:151], v163 offset:6144
  v_fma_f32 v120, v120, s44, -v164
  v_fma_f32 v121, v121, s44, -v164
  v_fma_f32 v122, v122, s44, -v164
  v_fma_f32 v123, v123, s44, -v164
  v_fma_f32 v124, v124, s44, -v164
  v_fma_f32 v125, v125, s44, -v164
  v_fma_f32 v126, v126, s44, -v164
  v_fma_f32 v127, v127, s44, -v164
  s_setprio 0
  s_waitcnt lgkmcnt(6)
  v_mfma_f32_32x32x16_bf16 v[0:15], v[136:139], v[132:135], v[0:15]
  v_add_u32 v160, 0x4000, v160
  ds_read_b128 v[136:139], v160
  v_exp_f32 v152, v112
  v_exp_f32 v153, v113
  v_mov_b32 v158, v152
  v_cvt_pk_bf16_f32 v128, v152, v153
  v_mov_b32 v159, v153
  s_waitcnt lgkmcnt(5)
  v_mfma_f32_32x32x16_bf16 v[16:31], v[140:143], v[132:135], v[16:31]
  v_xor_b32 v163, 32, v160
  ds_read_b128 v[140:143], v163
  v_exp_f32 v154, v114
  v_exp_f32 v155, v115
  v_add_f32 v158, v158, v154
  v_cvt_pk_bf16_f32 v129, v154, v155
  v_add_f32 v159, v159, v155
  s_waitcnt lgkmcnt(4)
  v_mfma_f32_32x32x16_bf16 v[32:47], v[144:147], v[132:135], v[32:47]
  v_xor_b32 v162, 64, v160
  ds_read_b128 v[144:147], v162
  v_exp_f32 v156, v116
  v_exp_f32 v157, v117
  v_add_f32 v158, v158, v156
  v_cvt_pk_bf16_f32 v130, v156, v157
  v_add_f32 v159, v159, v157
  s_waitcnt lgkmcnt(3)
  v_mfma_f32_32x32x16_bf16 v[48:63], v[148:151], v[132:135], v[48:63]
  v_xor_b32 v163, 96, v160
  ds_read_b128 v[148:151], v163
  v_exp_f32 v152, v118
  v_exp_f32 v153, v119
  v_add_f32 v158, v158, v152
  v_cvt_pk_bf16_f32 v131, v152, v153
  v_add_f32 v159, v159, v153
  s_cmp_lt_u32 s36, 8
  s_cbranch_scc1 K_wk3
  s_waitcnt vmcnt(4)
  s_branch K_go3
K_wk3:
  s_waitcnt vmcnt(2)
K_go3:
  s_barrier
  s_setprio 3
  s_waitcnt lgkmcnt(3)
  v_mfma_f32_32x32x16_bf16 v[96:111], v[136:139], v[64:67], 0
  v_xor_b32 v162, 128, v160
  ds_read_b128 v[136:139], v162
  v_exp_f32 v154, v120
  v_exp_f32 v155, v121
  s_waitcnt lgkmcnt(3)
  v_mfma_f32_32x32x16_bf16 v[96:111], v[140:143], v[68:71], v[96:111]
  v_xor_b32 v163, 160, v160
  ds_read_b128 v[140:143], v163
  v_add_f32 v158, v158, v154
  v_cvt_pk_bf16_f32 v132, v154, v155
  v_add_f32 v159, v159, v155
  s_cmp_lt_u32 s36, 8
  s_cbranch_scc1 K_dk7
  s_add_u32 s53, s3, 5
  s_and_b32 s53, s53, 7
  s_lshl_b32 s53, s53, 14
  s_add_u32 s53, s53, s39
  s_add_u32 s54, s47, 65536
  s_mov_b32 m0, s54
  s_nop 0
  buffer_load_dwordx4 v167, s[24:27], s53 offen nt lds
  s_add_u32 s53, s3, 5
  s_and_b32 s53, s53, 7
  s_lshl_b32 s53, s53, 14
  s_add_u32 s53, s53, s39
  s_add_u32 s53, s53, 4096
  s_add_u32 s54, s47, 69632
  s_mov_b32 m0, s54
  s_nop 0
  buffer_load_dwordx4 v167, s[24:27], s53 offen nt lds
  s_add_u32 s53, s3, 5
  s_and_b32 s53, s53, 7
  s_lshl_b32 s53, s53, 14
  s_add_u32 s53, s53, s39
  s_add_u32 s53, s53, 8192
  s_add_u32 s54, s47, 73728
  s_mov_b32 m0, s54
  s_nop 0
  buffer_load_dwordx4 v167, s[24:27], s53 offen nt lds
  s_add_u32 s53, s3, 5
  s_and_b32 s53, s53, 7
  s_lshl_b32 s53, s53, 14
  s_add_u32 s53, s53, s39
  s_add_u32 s53, s53, 12288
  s_add_u32 s54, s47, 77824
  s_mov_b32 m0, s54
  s_nop 0
  buffer_load_dwordx4 v167, s[24:27], s53 offen nt lds
  s_branch K_dd7
K_dk7:
  s_add_u32 s53, s3, 7
  s_and_b32 s53, s53, 7
  s_lshl_b32 s53, s53, 14
  s_add_u32 s53, s53, s39
  s_add_u32 s54, s47, 81920
  s_mov_b32 m0, s54
  s_nop 0
  buffer_load_dwordx4 v166, s[20:23], s53 offen nt lds
  s_add_u32 s53, s3, 7
  s_and_b32 s53, s53, 7
  s_lshl_b32 s53, s53, 14
  s_add_u32 s53, s53, s39
  s_add_u32 s53, s53, 8192
  s_add_u32 s54, s47, 90112
  s_mov_b32 m0, s54
  s_nop 0
  buffer_load_dwordx4 v166, s[20:23], s53 offen nt lds
K_dd7:
  s_waitcnt lgkmcnt(3)
  v_mfma_f32_32x32x16_bf16 v[96:111], v[144:147], v[72:75], v[96:111]
  v_xor_b32 v162, 192, v160
  ds_read_b128 v[144:147], v162
  v_exp_f32 v156, v122
  v_exp_f32 v157, v123
  s_waitcnt lgkmcnt(3)
  v_mfma_f32_32x32x16_bf16 v[96:111], v[148:151], v[76:79], v[96:111]
  v_xor_b32 v163, 224, v160
  ds_read_b128 v[148:151], v163
  v_add_f32 v158, v158, v156
  v_cvt_pk_bf16_f32 v133, v156, v157
  v_add_f32 v159, v159, v157
  s_setprio 2
  s_waitcnt lgkmcnt(3)
  v_mfma_f32_32x32x16_bf16 v[96:111], v[136:139], v[80:83], v[96:111]
  v_add_u32 v161, 0xffff0000, v161
  ds_read_b64_tr_b16 v[136:137], v161 offset:0
  ds_read_b64_tr_b16 v[138:139], v161 offset:2048
  v_exp_f32 v152, v124
  v_exp_f32 v153, v125
  s_waitcnt lgkmcnt(4)
  v_mfma_f32_32x32x16_bf16 v[96:111], v[140:143], v[84:87], v[96:111]
  v_xor_b32 v163, 64, v161
  ds_read_b64_tr_b16 v[140:141], v163 offset:0
  ds_read_b64_tr_b16 v[142:143], v163 offset:2048
  v_add_f32 v158, v158, v152
  v_cvt_pk_bf16_f32 v134, v152, v153
  v_add_f32 v159, v159, v153
  s_waitcnt lgkmcnt(5)
  v_mfma_f32_32x32x16_bf16 v[96:111], v[144:147], v[88:91], v[96:111]
  v_xor_b32 v162, 128, v161
  ds_read_b64_tr_b16 v[144:145], v162 offset:0
  ds_read_b64_tr_b16 v[146:147], v162 offset:2048
  v_exp_f32 v154, v126
  v_exp_f32 v155, v127
  s_waitcnt lgkmcnt(6)
  v_mfma_f32_32x32x16_bf16 v[96:111], v[148:151], v[92:95], v[96:111]
  v_xor_b32 v163, 192, v161
  ds_read_b64_tr_b16 v[148:149], v163 offset:0
  ds_read_b64_tr_b16 v[150:151], v163 offset:2048
  v_add_f32 v158, v158, v154
  v_cvt_pk_bf16_f32 v135, v154, v155
  v_add_f32 v159, v159, v155
  v_add_f32 v158, v158, v159
  v_cmp_nge_f32 vcc, 0x45800000, v158
  s_cbranch_vccnz K_rare3
K_back3:
  v_add_f32 v165, v165, v158
  s_setprio 1
  s_waitcnt lgkmcnt(6)
  v_mfma_f32_32x32x16_bf16 v[0:15], v[136:139], v[128:131], v[0:15]
  ds_read_b64_tr_b16 v[136:137], v161 offset:4096
  ds_read_b64_tr_b16 v[138:139], v161 offset:6144
  s_waitcnt lgkmcnt(6)
  v_mfma_f32_32x32x16_bf16 v[16:31], v[140:143], v[128:131], v[16:31]
  v_xor_b32 v163, 64, v161
  ds_read_b64_tr_b16 v[140:141], v163 offset:4096
  ds_read_b64_tr_b16 v[142:143], v163 offset:6144
  s_waitcnt lgkmcnt(6)
  v_mfma_f32_32x32x16_bf16 v[32:47], v[144:147], v[128:131], v[32:47]
  v_xor_b32 v162, 128, v161
  ds_read_b64_tr_b16 v[144:145], v162 offset:4096
  ds_read_b64_tr_b16 v[146:147], v162 offset:6144
  v_fma_f32 v96, v96, s44, -v164
  v_fma_f32 v97, v97, s44, -v164
  v_fma_f32 v98, v98, s44, -v164
  v_fma_f32 v99, v99, s44, -v164
  v_fma_f32 v100, v100, s44, -v164
  v_fma_f32 v101, v101, s44, -v164
  v_fma_f32 v102, v102, s44, -v164
  v_fma_f32 v103, v103, s44, -v164
  s_waitcnt lgkmcnt(6)
  v_mfma_f32_32x32x16_bf16 v[48:63], v[148:151], v[128:131], v[48:63]
  v_xor_b32 v163, 192, v161
  ds_read_b64_tr_b16 v[148:149], v163 offset:4096
  ds_read_b64_tr_b16 v[150:151], v163 offset:6144
  v_fma_f32 v104, v104, s44, -v164
  v_fma_f32 v105, v105, s44, -v164
  v_fma_f32 v106, v106, s44, -v164
  v_fma_f32 v107, v107, s44, -v164
  v_fma_f32 v108, v108, s44, -v164
  v_fma_f32 v109, v109, s44, -v164
  v_fma_f32 v110, v110, s44, -v164
  v_fma_f32 v111, v111, s44, -v164
  s_setprio 0
  s_waitcnt lgkmcnt(6)
  v_mfma_f32_32x32x16_bf16 v[0:15], v[136:139], v[132:135], v[0:15]
  v_add_u32 v160, 0x18000, v160
  ds_read_b128 v[136:139], v160
  v_exp_f32 v152, v96
  v_exp_f32 v153, v97
  v_mov_b32 v158, v152
  v_cvt_pk_bf16_f32 v128, v152, v153
  v_mov_b32 v159, v153
  s_waitcnt lgkmcnt(5)
  v_mfma_f32_32x32x16_bf16 v[16:31], v[140:143], v[132:135], v[16:31]
  v_xor_b32 v163, 32, v160
  ds_read_b128 v[140:143], v163
  v_exp_f32 v154, v98
  v_exp_f32 v155, v99
  v_add_f32 v158, v158, v154
  v_cvt_pk_bf16_f32 v129, v154, v155
  v_add_f32 v159, v159, v155
  s_waitcnt lgkmcnt(4)
  v_mfma_f32_32x32x16_bf16 v[32:47], v[144:147], v[132:135], v[32:47]
  v_xor_b32 v162, 64, v160
  ds_read_b128 v[144:147], v162
  v_exp_f32 v156, v100
  v_exp_f32 v157, v101
  v_add_f32 v158, v158, v156
  v_cvt_pk_bf16_f32 v130, v156, v157
  v_add_f32 v159, v159, v157
  s_waitcnt lgkmcnt(3)
  v_mfma_f32_32x32x16_bf16 v[48:63], v[148:151], v[132:135], v[48:63]
  v_xor_b32 v163, 96, v160
  ds_read_b128 v[148:151], v163
  v_exp_f32 v152, v102
  v_exp_f32 v153, v103
  v_add_f32 v158, v158, v152
  v_cvt_pk_bf16_f32 v131, v152, v153
  v_add_f32 v159, v159, v153
  s_cmp_lt_u32 s36, 8
  s_cbranch_scc1 K_wk4
  s_waitcnt vmcnt(4)
  s_branch K_go4
K_wk4:
  s_waitcnt vmcnt(2)
K_go4:
  s_barrier
  s_setprio 3
  s_waitcnt lgkmcnt(3)
  v_mfma_f32_32x32x16_bf16 v[112:127], v[136:139], v[64:67], 0
  v_xor_b32 v162, 128, v160
  ds_read_b128 v[136:139], v162
  v_exp_f32 v154, v104
  v_exp_f32 v155, v105
  s_waitcnt lgkmcnt(3)
  v_mfma_f32_32x32x16_bf16 v[112:127], v[140:143], v[68:71], v[112:127]
  v_xor_b32 v163, 160, v160
  ds_read_b128 v[140:143], v163
  v_add_f32 v158, v158, v154
  v_cvt_pk_bf16_f32 v132, v154, v155
  v_add_f32 v159, v159, v155
  s_cmp_lt_u32 s36, 8
  s_cbranch_scc1 K_dk8
  s_add_u32 s53, s3, 6
  s_and_b32 s53, s53, 7
  s_lshl_b32 s53, s53, 14
  s_add_u32 s53, s53, s39
  s_add_u32 s54, s47, 147456
  s_mov_b32 m0, s54
  s_nop 0
  buffer_load_dwordx4 v167, s[24:27], s53 offen nt lds
  s_add_u32 s53, s3, 6
  s_and_b32 s53, s53, 7
  s_lshl_b32 s53, s53, 14
  s_add_u32 s53, s53, s39
  s_add_u32 s53, s53, 4096
  s_add_u32 s54, s47, 151552
  s_mov_b32 m0, s54
  s_nop 0
  buffer_load_dwordx4 v167, s[24:27], s53 offen nt lds
  s_add_u32 s53, s3, 6
  s_and_b32 s53, s53, 7
  s_lshl_b32 s53, s53, 14
  s_add_u32 s53, s53, s39
  s_add_u32 s53, s53, 8192
  s_add_u32 s54, s47, 155648
  s_mov_b32 m0, s54
  s_nop 0
  buffer_load_dwordx4 v167, s[24:27], s53 offen nt lds
  s_add_u32 s53, s3, 6
  s_and_b32 s53, s53, 7
  s_lshl_b32 s53, s53, 14
  s_add_u32 s53, s53, s39
  s_add_u32 s53, s53, 12288
  s_add_u32 s54, s47, 159744
  s_mov_b32 m0, s54
  s_nop 0
  buffer_load_dwordx4 v167, s[24:27], s53 offen nt lds
  s_add_u32 s53, s3, 7
  s_and_b32 s53, s53, 7
  s_lshl_b32 s53, s53, 14
  s_add_u32 s53, s53, s39
  s_add_u32 s54, s47, 0
  s_mov_b32 m0, s54
  s_nop 0
  buffer_load_dwordx4 v167, s[24:27], s53 offen nt lds
  s_add_u32 s53, s3, 7
  s_and_b32 s53, s53, 7
  s_lshl_b32 s53, s53, 14
  s_add_u32 s53, s53, s39
  s_add_u32 s53, s53, 4096
  s_add_u32 s54, s47, 4096
  s_mov_b32 m0, s54
  s_nop 0
  buffer_load_dwordx4 v167, s[24:27], s53 offen nt lds
  s_add_u32 s53, s3, 7
  s_and_b32 s53, s53, 7
  s_lshl_b32 s53, s53, 14
  s_add_u32 s53, s53, s39
  s_add_u32 s53, s53, 8192
  s_add_u32 s54, s47, 8192
  s_mov_b32 m0, s54
  s_nop 0
  buffer_load_dwordx4 v167, s[24:27], s53 offen nt lds
  s_add_u32 s53, s3, 7
  s_and_b32 s53, s53, 7
  s_lshl_b32 s53, s53, 14
  s_add_u32 s53, s53, s39
  s_add_u32 s53, s53, 12288
  s_add_u32 s54, s47, 12288
  s_mov_b32 m0, s54
  s_nop 0
  buffer_load_dwordx4 v167, s[24:27], s53 offen nt lds
K_dk8:
  s_waitcnt lgkmcnt(3)
  v_mfma_f32_32x32x16_bf16 v[112:127], v[144:147], v[72:75], v[112:127]
  v_xor_b32 v162, 192, v160
  ds_read_b128 v[144:147], v162
  v_exp_f32 v156, v106
  v_exp_f32 v157, v107
  s_waitcnt lgkmcnt(3)
  v_mfma_f32_32x32x16_bf16 v[112:127], v[148:151], v[76:79], v[112:127]
  v_xor_b32 v163, 224, v160
  ds_read_b128 v[148:151], v163
  v_add_f32 v158, v158, v156
  v_cvt_pk_bf16_f32 v133, v156, v157
  v_add_f32 v159, v159, v157
  s_setprio 2
  s_waitcnt lgkmcnt(3)
  v_mfma_f32_32x32x16_bf16 v[112:127], v[136:139], v[80:83], v[112:127]
  v_add_u32 v161, 0x4000, v161
  ds_read_b64_tr_b16 v[136:137], v161 offset:0
  ds_read_b64_tr_b16 v[138:139], v161 offset:2048
  v_exp_f32 v152, v108
  v_exp_f32 v153, v109
  s_waitcnt lgkmcnt(4)
  v_mfma_f32_32x32x16_bf16 v[112:127], v[140:143], v[84:87], v[112:127]
  v_xor_b32 v163, 64, v161
  ds_read_b64_tr_b16 v[140:141], v163 offset:0
  ds_read_b64_tr_b16 v[142:143], v163 offset:2048
  v_add_f32 v158, v158, v152
  v_cvt_pk_bf16_f32 v134, v152, v153
  v_add_f32 v159, v159, v153
  s_waitcnt lgkmcnt(5)
  v_mfma_f32_32x32x16_bf16 v[112:127], v[144:147], v[88:91], v[112:127]
  v_xor_b32 v162, 128, v161
  ds_read_b64_tr_b16 v[144:145], v162 offset:0
  ds_read_b64_tr_b16 v[146:147], v162 offset:2048
  v_exp_f32 v154, v110
  v_exp_f32 v155, v111
  s_waitcnt lgkmcnt(6)
  v_mfma_f32_32x32x16_bf16 v[112:127], v[148:151], v[92:95], v[112:127]
  v_xor_b32 v163, 192, v161
  ds_read_b64_tr_b16 v[148:149], v163 offset:0
  ds_read_b64_tr_b16 v[150:151], v163 offset:2048
  v_add_f32 v158, v158, v154
  v_cvt_pk_bf16_f32 v135, v154, v155
  v_add_f32 v159, v159, v155
  v_add_f32 v158, v158, v159
  v_cmp_nge_f32 vcc, 0x45800000, v158
  s_cbranch_vccnz K_rare4
K_back4:
  v_add_f32 v165, v165, v158
  s_setprio 1
  s_waitcnt lgkmcnt(6)
  v_mfma_f32_32x32x16_bf16 v[0:15], v[136:139], v[128:131], v[0:15]
  ds_read_b64_tr_b16 v[136:137], v161 offset:4096
  ds_read_b64_tr_b16 v[138:139], v161 offset:6144
  s_waitcnt lgkmcnt(6)
  v_mfma_f32_32x32x16_bf16 v[16:31], v[140:143], v[128:131], v[16:31]
  v_xor_b32 v163, 64, v161
  ds_read_b64_tr_b16 v[140:141], v163 offset:4096
  ds_read_b64_tr_b16 v[142:143], v163 offset:6144
  s_waitcnt lgkmcnt(6)
  v_mfma_f32_32x32x16_bf16 v[32:47], v[144:147], v[128:131], v[32:47]
  v_xor_b32 v162, 128, v161
  ds_read_b64_tr_b16 v[144:145], v162 offset:4096
  ds_read_b64_tr_b16 v[146:147], v162 offset:6144
  v_fma_f32 v112, v112, s44, -v164
  v_fma_f32 v113, v113, s44, -v164
  v_fma_f32 v114, v114, s44, -v164
  v_fma_f32 v115, v115, s44, -v164
  v_fma_f32 v116, v116, s44, -v164
  v_fma_f32 v117, v117, s44, -v164
  v_fma_f32 v118, v118, s44, -v164
  v_fma_f32 v119, v119, s44, -v164
  s_waitcnt lgkmcnt(6)
  v_mfma_f32_32x32x16_bf16 v[48:63], v[148:151], v[128:131], v[48:63]
  v_xor_b32 v163, 192, v161
  ds_read_b64_tr_b16 v[148:149], v163 offset:4096
  ds_read_b64_tr_b16 v[150:151], v163 offset:6144
  v_fma_f32 v120, v120, s44, -v164
  v_fma_f32 v121, v121, s44, -v164
  v_fma_f32 v122, v122, s44, -v164
  v_fma_f32 v123, v123, s44, -v164
  v_fma_f32 v124, v124, s44, -v164
  v_fma_f32 v125, v125, s44, -v164
  v_fma_f32 v126, v126, s44, -v164
  v_fma_f32 v127, v127, s44, -v164
  s_setprio 0
  s_waitcnt lgkmcnt(6)
  v_mfma_f32_32x32x16_bf16 v[0:15], v[136:139], v[132:135], v[0:15]
  v_add_u32 v160, 0x4000, v160
  ds_read_b128 v[136:139], v160
  v_exp_f32 v152, v112
  v_exp_f32 v153, v113
  v_mov_b32 v158, v152
  v_cvt_pk_bf16_f32 v128, v152, v153
  v_mov_b32 v159, v153
  s_waitcnt lgkmcnt(5)
  v_mfma_f32_32x32x16_bf16 v[16:31], v[140:143], v[132:135], v[16:31]
  v_xor_b32 v163, 32, v160
  ds_read_b128 v[140:143], v163
  v_exp_f32 v154, v114
  v_exp_f32 v155, v115
  v_add_f32 v158, v158, v154
  v_cvt_pk_bf16_f32 v129, v154, v155
  v_add_f32 v159, v159, v155
  s_waitcnt lgkmcnt(4)
  v_mfma_f32_32x32x16_bf16 v[32:47], v[144:147], v[132:135], v[32:47]
  v_xor_b32 v162, 64, v160
  ds_read_b128 v[144:147], v162
  v_exp_f32 v156, v116
  v_exp_f32 v157, v117
  v_add_f32 v158, v158, v156
  v_cvt_pk_bf16_f32 v130, v156, v157
  v_add_f32 v159, v159, v157
  s_waitcnt lgkmcnt(3)
  v_mfma_f32_32x32x16_bf16 v[48:63], v[148:151], v[132:135], v[48:63]
  v_xor_b32 v163, 96, v160
  ds_read_b128 v[148:151], v163
  v_exp_f32 v152, v118
  v_exp_f32 v153, v119
  v_add_f32 v158, v158, v152
  v_cvt_pk_bf16_f32 v131, v152, v153
  v_add_f32 v159, v159, v153
  s_cmp_lt_u32 s36, 8
  s_cbranch_scc1 K_nwo
  s_lshr_b32 s60, s40, 1
  s_mul_i32 s60, s60, 1310720
  s_mul_i32 s61, s41, 40960
  s_add_u32 s60, s60, s61
  s_mul_i32 s61, s45, 10240
  s_add_u32 s60, s60, s61
  v_mbcnt_lo_u32_b32 v166, -1, 0
  v_mbcnt_hi_u32_b32 v166, -1, v166
  v_lshlrev_b32 v166, 7, v166
  buffer_load_dword v167, v166, s[4:7], s60 offen
  buffer_load_dword v167, v166, s[4:7], s60 offen offset:2048
  buffer_load_dword v166, off, s[12:15], 0 offset:240 sc1
K_nwo:
  s_setprio 3
  s_waitcnt lgkmcnt(3)
  v_mfma_f32_32x32x16_bf16 v[96:111], v[136:139], v[64:67], 0
  v_xor_b32 v162, 128, v160
  ds_read_b128 v[136:139], v162
  v_exp_f32 v154, v120
  v_exp_f32 v155, v121
  s_waitcnt lgkmcnt(3)
  v_mfma_f32_32x32x16_bf16 v[96:111], v[140:143], v[68:71], v[96:111]
  v_xor_b32 v163, 160, v160
  ds_read_b128 v[140:143], v163
  v_add_f32 v158, v158, v154
  v_cvt_pk_bf16_f32 v132, v154, v155
  v_add_f32 v159, v159, v155
  s_waitcnt lgkmcnt(3)
  v_mfma_f32_32x32x16_bf16 v[96:111], v[144:147], v[72:75], v[96:111]
  v_xor_b32 v162, 192, v160
  ds_read_b128 v[144:147], v162
  v_exp_f32 v156, v122
  v_exp_f32 v157, v123
  s_waitcnt lgkmcnt(3)
  v_mfma_f32_32x32x16_bf16 v[96:111], v[148:151], v[76:79], v[96:111]
  v_xor_b32 v163, 224, v160
  ds_read_b128 v[148:151], v163
  v_add_f32 v158, v158, v156
  v_cvt_pk_bf16_f32 v133, v156, v157
  v_add_f32 v159, v159, v157
  s_cmp_lt_u32 s36, 8
  s_cbranch_scc1 K_ubq6
  s_waitcnt vmcnt(11)
K_ubq6:
  s_barrier
  s_setprio 2
  s_waitcnt lgkmcnt(3)
  v_mfma_f32_32x32x16_bf16 v[96:111], v[136:139], v[80:83], v[96:111]
  v_add_u32 v161, 0x4000, v161
  ds_read_b64_tr_b16 v[136:137], v161 offset:0
  ds_read_b64_tr_b16 v[138:139], v161 offset:2048
  v_exp_f32 v152, v124
  v_exp_f32 v153, v125
  s_waitcnt lgkmcnt(4)
  v_mfma_f32_32x32x16_bf16 v[96:111], v[140:143], v[84:87], v[96:111]
  v_xor_b32 v163, 64, v161
  ds_read_b64_tr_b16 v[140:141], v163 offset:0
  ds_read_b64_tr_b16 v[142:143], v163 offset:2048
  v_add_f32 v158, v158, v152
  v_cvt_pk_bf16_f32 v134, v152, v153
  v_add_f32 v159, v159, v153
  s_waitcnt lgkmcnt(5)
  v_mfma_f32_32x32x16_bf16 v[96:111], v[144:147], v[88:91], v[96:111]
  v_xor_b32 v162, 128, v161
  ds_read_b64_tr_b16 v[144:145], v162 offset:0
  ds_read_b64_tr_b16 v[146:147], v162 offset:2048
  v_exp_f32 v154, v126
  v_exp_f32 v155, v127
  s_waitcnt lgkmcnt(6)
  v_mfma_f32_32x32x16_bf16 v[96:111], v[148:151], v[92:95], v[96:111]
  v_xor_b32 v163, 192, v161
  ds_read_b64_tr_b16 v[148:149], v163 offset:0
  ds_read_b64_tr_b16 v[150:151], v163 offset:2048
  v_add_f32 v158, v158, v154
  v_cvt_pk_bf16_f32 v135, v154, v155
  v_add_f32 v159, v159, v155
  v_add_f32 v158, v158, v159
  v_cmp_nge_f32 vcc, 0x45800000, v158
  s_cbranch_vccnz K_rare5
K_back5:
  v_add_f32 v165, v165, v158
  s_setprio 1
  s_waitcnt lgkmcnt(6)
  v_mfma_f32_32x32x16_bf16 v[0:15], v[136:139], v[128:131], v[0:15]
  ds_read_b64_tr_b16 v[136:137], v161 offset:4096
  ds_read_b64_tr_b16 v[138:139], v161 offset:6144
  s_waitcnt lgkmcnt(6)
  v_mfma_f32_32x32x16_bf16 v[16:31], v[140:143], v[128:131], v[16:31]
  v_xor_b32 v163, 64, v161
  ds_read_b64_tr_b16 v[140:141], v163 offset:4096
  ds_read_b64_tr_b16 v[142:143], v163 offset:6144
  s_waitcnt lgkmcnt(6)
  v_mfma_f32_32x32x16_bf16 v[32:47], v[144:147], v[128:131], v[32:47]
  v_xor_b32 v162, 128, v161
  ds_read_b64_tr_b16 v[144:145], v162 offset:4096
  ds_read_b64_tr_b16 v[146:147], v162 offset:6144
  v_fma_f32 v96, v96, s44, -v164
  v_fma_f32 v97, v97, s44, -v164
  v_fma_f32 v98, v98, s44, -v164
  v_fma_f32 v99, v99, s44, -v164
  v_fma_f32 v100, v100, s44, -v164
  v_fma_f32 v101, v101, s44, -v164
  v_fma_f32 v102, v102, s44, -v164
  v_fma_f32 v103, v103, s44, -v164
  s_waitcnt lgkmcnt(6)
  v_mfma_f32_32x32x16_bf16 v[48:63], v[148:151], v[128:131], v[48:63]
  v_xor_b32 v163, 192, v161
  ds_read_b64_tr_b16 v[148:149], v163 offset:4096
  ds_read_b64_tr_b16 v[150:151], v163 offset:6144
  v_fma_f32 v104, v104, s44, -v164
  v_fma_f32 v105, v105, s44, -v164
  v_fma_f32 v106, v106, s44, -v164
  v_fma_f32 v107, v107, s44, -v164
  v_fma_f32 v108, v108, s44, -v164
  v_fma_f32 v109, v109, s44, -v164
  v_fma_f32 v110, v110, s44, -v164
  v_fma_f32 v111, v111, s44, -v164
  s_cmp_ge_u32 s36, 8
  s_cbranch_scc1 K_ubp6
  s_waitcnt vmcnt(0)
K_ubp6:
  s_barrier
  s_setprio 0
  s_waitcnt lgkmcnt(6)
  v_mfma_f32_32x32x16_bf16 v[0:15], v[136:139], v[132:135], v[0:15]
  v_add_u32 v160, 0xffff4000, v160
  ds_read_b128 v[136:139], v160
  v_exp_f32 v152, v96
  v_exp_f32 v153, v97
  v_mov_b32 v158, v152
  v_cvt_pk_bf16_f32 v128, v152, v153
  v_mov_b32 v159, v153
  s_waitcnt lgkmcnt(5)
  v_mfma_f32_32x32x16_bf16 v[16:31], v[140:143], v[132:135], v[16:31]
  v_xor_b32 v163, 32, v160
  ds_read_b128 v[140:143], v163
  v_exp_f32 v154, v98
  v_exp_f32 v155, v99
  v_add_f32 v158, v158, v154
  v_cvt_pk_bf16_f32 v129, v154, v155
  v_add_f32 v159, v159, v155
  s_waitcnt lgkmcnt(4)
  v_mfma_f32_32x32x16_bf16 v[32:47], v[144:147], v[132:135], v[32:47]
  v_xor_b32 v162, 64, v160
  ds_read_b128 v[144:147], v162
  v_exp_f32 v156, v100
  v_exp_f32 v157, v101
  v_add_f32 v158, v158, v156
  v_cvt_pk_bf16_f32 v130, v156, v157
  v_add_f32 v159, v159, v157
  s_waitcnt lgkmcnt(3)
  v_mfma_f32_32x32x16_bf16 v[48:63], v[148:151], v[132:135], v[48:63]
  v_xor_b32 v163, 96, v160
  ds_read_b128 v[148:151], v163
  v_exp_f32 v152, v102
  v_exp_f32 v153, v103
  v_add_f32 v158, v158, v152
  v_cvt_pk_bf16_f32 v131, v152, v153
  v_add_f32 v159, v159, v153
  s_setprio 3
  s_waitcnt lgkmcnt(3)
  v_mfma_f32_32x32x16_bf16 v[112:127], v[136:139], v[64:67], 0
  v_xor_b32 v162, 128, v160
  ds_read_b128 v[136:139], v162
  v_exp_f32 v154, v104
  v_exp_f32 v155, v105
  s_waitcnt lgkmcnt(3)
  v_mfma_f32_32x32x16_bf16 v[112:127], v[140:143], v[68:71], v[112:127]
  v_xor_b32 v163, 160, v160
  ds_read_b128 v[140:143], v163
  v_add_f32 v158, v158, v154
  v_cvt_pk_bf16_f32 v132, v154, v155
  v_add_f32 v159, v159, v155
  s_waitcnt lgkmcnt(3)
  v_mfma_f32_32x32x16_bf16 v[112:127], v[144:147], v[72:75], v[112:127]
  v_xor_b32 v162, 192, v160
  ds_read_b128 v[144:147], v162
  v_exp_f32 v156, v106
  v_exp_f32 v157, v107
  s_waitcnt lgkmcnt(3)
  v_mfma_f32_32x32x16_bf16 v[112:127], v[148:151], v[76:79], v[112:127]
  v_xor_b32 v163, 224, v160
  ds_read_b128 v[148:151], v163
  v_add_f32 v158, v158, v156
  v_cvt_pk_bf16_f32 v133, v156, v157
  v_add_f32 v159, v159, v157
  s_cmp_lt_u32 s36, 8
  s_cbranch_scc1 K_ubq7
  s_waitcnt vmcnt(7)
K_ubq7:
  s_barrier
  s_setprio 2
  s_waitcnt lgkmcnt(3)
  v_mfma_f32_32x32x16_bf16 v[112:127], v[136:139], v[80:83], v[112:127]
  v_add_u32 v161, 0x14000, v161
  ds_read_b64_tr_b16 v[136:137], v161 offset:0
  ds_read_b64_tr_b16 v[138:139], v161 offset:2048
  v_exp_f32 v152, v108
  v_exp_f32 v153, v109
  s_waitcnt lgkmcnt(4)
  v_mfma_f32_32x32x16_bf16 v[112:127], v[140:143], v[84:87], v[112:127]
  v_xor_b32 v163, 64, v161
  ds_read_b64_tr_b16 v[140:141], v163 offset:0
  ds_read_b64_tr_b16 v[142:143], v163 offset:2048
  v_add_f32 v158, v158, v152
  v_cvt_pk_bf16_f32 v134, v152, v153
  v_add_f32 v159, v159, v153
  s_waitcnt lgkmcnt(5)
  v_mfma_f32_32x32x16_bf16 v[112:127], v[144:147], v[88:91], v[112:127]
  v_xor_b32 v162, 128, v161
  ds_read_b64_tr_b16 v[144:145], v162 offset:0
  ds_read_b64_tr_b16 v[146:147], v162 offset:2048
  v_exp_f32 v154, v110
  v_exp_f32 v155, v111
  s_waitcnt lgkmcnt(6)
  v_mfma_f32_32x32x16_bf16 v[112:127], v[148:151], v[92:95], v[112:127]
  v_xor_b32 v163, 192, v161
  ds_read_b64_tr_b16 v[148:149], v163 offset:0
  ds_read_b64_tr_b16 v[150:151], v163 offset:2048
  v_add_f32 v158, v158, v154
  v_cvt_pk_bf16_f32 v135, v154, v155
  v_add_f32 v159, v159, v155
  v_add_f32 v158, v158, v159
  v_cmp_nge_f32 vcc, 0x45800000, v158
  s_cbranch_vccnz K_rare6
K_back6:
  v_add_f32 v165, v165, v158
  s_setprio 1
  s_waitcnt lgkmcnt(6)
  v_mfma_f32_32x32x16_bf16 v[0:15], v[136:139], v[128:131], v[0:15]
  ds_read_b64_tr_b16 v[136:137], v161 offset:4096
  ds_read_b64_tr_b16 v[138:139], v161 offset:6144
  s_waitcnt lgkmcnt(6)
  v_mfma_f32_32x32x16_bf16 v[16:31], v[140:143], v[128:131], v[16:31]
  v_xor_b32 v163, 64, v161
  ds_read_b64_tr_b16 v[140:141], v163 offset:4096
  ds_read_b64_tr_b16 v[142:143], v163 offset:6144
  s_waitcnt lgkmcnt(6)
  v_mfma_f32_32x32x16_bf16 v[32:47], v[144:147], v[128:131], v[32:47]
  v_xor_b32 v162, 128, v161
  ds_read_b64_tr_b16 v[144:145], v162 offset:4096
  ds_read_b64_tr_b16 v[146:147], v162 offset:6144
  v_fma_f32 v112, v112, s44, -v164
  v_fma_f32 v113, v113, s44, -v164
  v_fma_f32 v114, v114, s44, -v164
  v_fma_f32 v115, v115, s44, -v164
  v_fma_f32 v116, v116, s44, -v164
  v_fma_f32 v117, v117, s44, -v164
  v_fma_f32 v118, v118, s44, -v164
  v_fma_f32 v119, v119, s44, -v164
  s_waitcnt lgkmcnt(6)
  v_mfma_f32_32x32x16_bf16 v[48:63], v[148:151], v[128:131], v[48:63]
  v_xor_b32 v163, 192, v161
  ds_read_b64_tr_b16 v[148:149], v163 offset:4096
  ds_read_b64_tr_b16 v[150:151], v163 offset:6144
  v_fma_f32 v120, v120, s44, -v164
  v_fma_f32 v121, v121, s44, -v164
  v_fma_f32 v122, v122, s44, -v164
  v_fma_f32 v123, v123, s44, -v164
  v_fma_f32 v124, v124, s44, -v164
  v_fma_f32 v125, v125, s44, -v164
  v_fma_f32 v126, v126, s44, -v164
  v_fma_f32 v127, v127, s44, -v164
  s_cmp_lt_u32 s36, 8
  s_cbranch_scc1 K_ubp7
  s_waitcnt vmcnt(3)
K_ubp7:
  s_barrier
  s_setprio 0
  s_waitcnt lgkmcnt(6)
  v_mfma_f32_32x32x16_bf16 v[0:15], v[136:139], v[132:135], v[0:15]
  v_add_u32 v161, 0xfffdc000, v161
  ds_read_b64_tr_b16 v[136:137], v161 offset:0
  ds_read_b64_tr_b16 v[138:139], v161 offset:2048
  v_exp_f32 v152, v112
  v_exp_f32 v153, v113
  v_mov_b32 v158, v152
  v_cvt_pk_bf16_f32 v128, v152, v153
  v_mov_b32 v159, v153
  s_waitcnt lgkmcnt(6)
  v_mfma_f32_32x32x16_bf16 v[16:31], v[140:143], v[132:135], v[16:31]
  v_xor_b32 v163, 64, v161
  ds_read_b64_tr_b16 v[140:141], v163 offset:0
  ds_read_b64_tr_b16 v[142:143], v163 offset:2048
  v_exp_f32 v154, v114
  v_exp_f32 v155, v115
  v_add_f32 v158, v158, v154
  v_cvt_pk_bf16_f32 v129, v154, v155
  v_add_f32 v159, v159, v155
  s_waitcnt lgkmcnt(6)
  v_mfma_f32_32x32x16_bf16 v[32:47], v[144:147], v[132:135], v[32:47]
  v_xor_b32 v162, 128, v161
  ds_read_b64_tr_b16 v[144:145], v162 offset:0
  ds_read_b64_tr_b16 v[146:147], v162 offset:2048
  v_exp_f32 v156, v116
  v_exp_f32 v157, v117
  v_add_f32 v158, v158, v156
  v_cvt_pk_bf16_f32 v130, v156, v157
  v_add_f32 v159, v159, v157
  s_waitcnt lgkmcnt(6)
  v_mfma_f32_32x32x16_bf16 v[48:63], v[148:151], v[132:135], v[48:63]
  v_xor_b32 v163, 192, v161
  ds_read_b64_tr_b16 v[148:149], v163 offset:0
  ds_read_b64_tr_b16 v[150:151], v163 offset:2048
  v_exp_f32 v152, v118
  v_exp_f32 v153, v119
  v_add_f32 v158, v158, v152
  v_cvt_pk_bf16_f32 v131, v152, v153
  v_add_f32 v159, v159, v153
  s_setprio 3
  v_exp_f32 v154, v120
  v_exp_f32 v155, v121
  v_add_f32 v158, v158, v154
  v_cvt_pk_bf16_f32 v132, v154, v155
  v_add_f32 v159, v159, v155
  v_exp_f32 v156, v122
  v_exp_f32 v157, v123
  v_add_f32 v158, v158, v156
  v_cvt_pk_bf16_f32 v133, v156, v157
  v_add_f32 v159, v159, v157
  v_exp_f32 v152, v124
  v_exp_f32 v153, v125
  v_add_f32 v158, v158, v152
  v_cvt_pk_bf16_f32 v134, v152, v153
  v_add_f32 v159, v159, v153
  v_exp_f32 v154, v126
  v_exp_f32 v155, v127
  v_add_f32 v158, v158, v154
  v_cvt_pk_bf16_f32 v135, v154, v155
  v_add_f32 v159, v159, v155
  v_add_f32 v158, v158, v159
  v_cmp_nge_f32 vcc, 0x45800000, v158
  s_cbranch_vccnz K_rare7
K_back7:
  v_add_f32 v165, v165, v158
  s_nop 0
  s_setprio 1
  s_waitcnt lgkmcnt(6)
  v_mfma_f32_32x32x16_bf16 v[0:15], v[136:139], v[128:131], v[0:15]
  ds_read_b64_tr_b16 v[136:137], v161 offset:4096
  ds_read_b64_tr_b16 v[138:139], v161 offset:6144
  s_waitcnt lgkmcnt(6)
  v_mfma_f32_32x32x16_bf16 v[16:31], v[140:143], v[128:131], v[16:31]
  v_xor_b32 v163, 64, v161
  ds_read_b64_tr_b16 v[140:141], v163 offset:4096
  ds_read_b64_tr_b16 v[142:143], v163 offset:6144
  s_waitcnt lgkmcnt(6)
  v_mfma_f32_32x32x16_bf16 v[32:47], v[144:147], v[128:131], v[32:47]
  v_xor_b32 v162, 128, v161
  ds_read_b64_tr_b16 v[144:145], v162 offset:4096
  ds_read_b64_tr_b16 v[146:147], v162 offset:6144
  s_waitcnt lgkmcnt(6)
  v_mfma_f32_32x32x16_bf16 v[48:63], v[148:151], v[128:131], v[48:63]
  v_xor_b32 v163, 192, v161
  ds_read_b64_tr_b16 v[148:149], v163 offset:4096
  ds_read_b64_tr_b16 v[150:151], v163 offset:6144
  s_setprio 0
  s_waitcnt lgkmcnt(6)
  v_mfma_f32_32x32x16_bf16 v[0:15], v[136:139], v[132:135], v[0:15]
  s_waitcnt lgkmcnt(4)
  v_mfma_f32_32x32x16_bf16 v[16:31], v[140:143], v[132:135], v[16:31]
  s_waitcnt lgkmcnt(2)
  v_mfma_f32_32x32x16_bf16 v[32:47], v[144:147], v[132:135], v[32:47]
  s_waitcnt lgkmcnt(0)
  v_mfma_f32_32x32x16_bf16 v[48:63], v[148:151], v[132:135], v[48:63]
  s_waitcnt vmcnt(0)
  v_readfirstlane_b32 s63, v166
  v_mov_b32 v163, v165
  s_nop 1
  v_permlane32_swap_b32 v165, v163
  s_nop 1
  v_add_f32 v165, v165, v163
  s_mul_i32 s55, s36, 8704
  s_add_u32 s57, s55, 37376
  s_add_u32 s55, s55, 16384
  s_cmp_lt_u32 s36, 7
  s_cselect_b32 s55, s55, s57
  s_xor_b32 s58, s36, 1
  s_mul_i32 s56, s58, 8704
  s_add_u32 s57, s56, 37376
  s_add_u32 s56, s56, 16384
  s_cmp_lt_u32 s58, 7
  s_cselect_b32 s56, s56, s57
  v_mbcnt_lo_u32_b32 v166, -1, 0
  v_mbcnt_hi_u32_b32 v166, -1, v166
  v_lshlrev_b32 v167, 4, v166
  v_add_u32 v160, s55, v167
  v_add_u32 v161, s56, v167
  v_lshlrev_b32 v162, 3, v166
  v_add_u32 v163, s56, v162
  v_add_u32 v162, s55, v162
  ds_write_b64 v162, v[164:165] offset:8192
  s_nop 7
  ds_write_b128 v160, v[32:35] offset:0
  ds_write_b128 v160, v[36:39] offset:1024
  ds_write_b128 v160, v[40:43] offset:2048
  ds_write_b128 v160, v[44:47] offset:3072
  ds_write_b128 v160, v[48:51] offset:4096
  ds_write_b128 v160, v[52:55] offset:5120
  ds_write_b128 v160, v[56:59] offset:6144
  ds_write_b128 v160, v[60:63] offset:7168
  s_waitcnt lgkmcnt(0)
  s_barrier
  ds_read_b64 v[96:97], v163 offset:8192
  ds_read_b128 v[32:35], v161 offset:0
  ds_read_b128 v[36:39], v161 offset:1024
  ds_read_b128 v[40:43], v161 offset:2048
  ds_read_b128 v[44:47], v161 offset:3072
  ds_read_b128 v[48:51], v161 offset:4096
  ds_read_b128 v[52:55], v161 offset:5120
  ds_read_b128 v[56:59], v161 offset:6144
  ds_read_b128 v[60:63], v161 offset:7168
  s_waitcnt lgkmcnt(8)
  v_max_f32 v98, v164, v96
  v_sub_f32 v99, v164, v98
  v_sub_f32 v100, v96, v98
  v_exp_f32 v99, v99
  v_exp_f32 v100, v100
  s_nop 0
  v_mul_f32 v101, v99, v165
  v_fma_f32 v101, v100, v97, v101
  v_rcp_f32 v101, v101
  s_nop 0
  v_mul_f32 v99, v99, v101
  v_mul_f32 v100, v100, v101
  s_mul_i32 s55, s37, 6
  s_add_u32 s55, s55, s48
  s_lshl_b32 s55, s55, 8
  s_lshl_b32 s56, s38, 3
  s_add_u32 s55, s55, s56
  s_lshl_b32 s56, s49, 2
  s_add_u32 s55, s55, s56
  s_lshl_b32 s55, s55, 10
  s_waitcnt lgkmcnt(6)
  v_mul_f32 v0, v99, v0
  v_fma_f32 v0, v100, v32, v0
  v_mul_f32 v1, v99, v1
  v_fma_f32 v1, v100, v33, v1
  v_mul_f32 v2, v99, v2
  v_fma_f32 v2, v100, v34, v2
  v_mul_f32 v3, v99, v3
  v_fma_f32 v3, v100, v35, v3
  v_mul_f32 v4, v99, v4
  v_fma_f32 v4, v100, v36, v4
  v_mul_f32 v5, v99, v5
  v_fma_f32 v5, v100, v37, v5
  v_mul_f32 v6, v99, v6
  v_fma_f32 v6, v100, v38, v6
  v_mul_f32 v7, v99, v7
  v_fma_f32 v7, v100, v39, v7
  v_cvt_pk_bf16_f32 v64, v0, v1
  v_cvt_pk_bf16_f32 v65, v2, v3
  v_cvt_pk_bf16_f32 v66, v4, v5
  v_cvt_pk_bf16_f32 v67, v6, v7
  buffer_store_dwordx4 v[64:67], v167, s[32:35], s55 offen offset:0 sc1
  s_waitcnt lgkmcnt(4)
  v_mul_f32 v8, v99, v8
  v_fma_f32 v8, v100, v40, v8
  v_mul_f32 v9, v99, v9
  v_fma_f32 v9, v100, v41, v9
  v_mul_f32 v10, v99, v10
  v_fma_f32 v10, v100, v42, v10
  v_mul_f32 v11, v99, v11
  v_fma_f32 v11, v100, v43, v11
  v_mul_f32 v12, v99, v12
  v_fma_f32 v12, v100, v44, v12
  v_mul_f32 v13, v99, v13
  v_fma_f32 v13, v100, v45, v13
  v_mul_f32 v14, v99, v14
  v_fma_f32 v14, v100, v46, v14
  v_mul_f32 v15, v99, v15
  v_fma_f32 v15, v100, v47, v15
  v_cvt_pk_bf16_f32 v68, v8, v9
  v_cvt_pk_bf16_f32 v69, v10, v11
  v_cvt_pk_bf16_f32 v70, v12, v13
  v_cvt_pk_bf16_f32 v71, v14, v15
  buffer_store_dwordx4 v[68:71], v167, s[32:35], s55 offen offset:1024 sc1
  s_waitcnt lgkmcnt(2)
  v_mul_f32 v16, v99, v16
  v_fma_f32 v16, v100, v48, v16
  v_mul_f32 v17, v99, v17
  v_fma_f32 v17, v100, v49, v17
  v_mul_f32 v18, v99, v18
  v_fma_f32 v18, v100, v50, v18
  v_mul_f32 v19, v99, v19
  v_fma_f32 v19, v100, v51, v19
  v_mul_f32 v20, v99, v20
  v_fma_f32 v20, v100, v52, v20
  v_mul_f32 v21, v99, v21
  v_fma_f32 v21, v100, v53, v21
  v_mul_f32 v22, v99, v22
  v_fma_f32 v22, v100, v54, v22
  v_mul_f32 v23, v99, v23
  v_fma_f32 v23, v100, v55, v23
  v_cvt_pk_bf16_f32 v72, v16, v17
  v_cvt_pk_bf16_f32 v73, v18, v19
  v_cvt_pk_bf16_f32 v74, v20, v21
  v_cvt_pk_bf16_f32 v75, v22, v23
  buffer_store_dwordx4 v[72:75], v167, s[32:35], s55 offen offset:2048 sc1
  s_waitcnt lgkmcnt(0)
  v_mul_f32 v24, v99, v24
  v_fma_f32 v24, v100, v56, v24
  v_mul_f32 v25, v99, v25
  v_fma_f32 v25, v100, v57, v25
  v_mul_f32 v26, v99, v26
  v_fma_f32 v26, v100, v58, v26
  v_mul_f32 v27, v99, v27
  v_fma_f32 v27, v100, v59, v27
  v_mul_f32 v28, v99, v28
  v_fma_f32 v28, v100, v60, v28
  v_mul_f32 v29, v99, v29
  v_fma_f32 v29, v100, v61, v29
  v_mul_f32 v30, v99, v30
  v_fma_f32 v30, v100, v62, v30
  v_mul_f32 v31, v99, v31
  v_fma_f32 v31, v100, v63, v31
  v_cvt_pk_bf16_f32 v76, v24, v25
  v_cvt_pk_bf16_f32 v77, v26, v27
  v_cvt_pk_bf16_f32 v78, v28, v29
  v_cvt_pk_bf16_f32 v79, v30, v31
  buffer_store_dwordx4 v[76:79], v167, s[32:35], s55 offen offset:3072 sc1
  s_cmp_lt_u32 s36, 8
  s_cbranch_scc1 K_poll0_ok
  s_cmp_ge_u32 s63, 92
  s_cbranch_scc1 K_poll0_ok
  s_mov_b32 s61, 0
K_poll0:
  buffer_load_dword v100, off, s[12:15], 0 offset:240 sc1
  s_waitcnt vmcnt(0)
  v_readfirstlane_b32 s62, v100
  s_add_u32 s61, s61, 1
  s_cmp_ge_u32 s62, 92
  s_cbranch_scc1 K_poll0_ok
  s_cmp_ge_u32 s61, 20000
  s_cbranch_scc1 K_poll0_ok
  s_sleep 8
  s_branch K_poll0
K_poll0_ok:
  s_waitcnt vmcnt(0)
  s_barrier
  s_setprio 0
  s_cmp_lt_u32 s36, 8
  s_cbranch_scc1 K_pc
  s_cmp_eq_u32 s36, 8
  s_cbranch_scc0 K_fin
  s_lshl_b32 s55, s37, 2
  s_lshr_b32 s56, s38, 3
  s_add_u32 s55, s55, s56
  s_lshl_b32 s55, s55, 8
  s_add_u32 s55, s55, 50331648
  v_mov_b32 v1, 1
  s_mov_b64 exec, 1
  buffer_atomic_add v1, off, s[32:35], s55 sc1
  s_mov_b64 exec, -1
  s_branch K_fin
K_pc:
  s_cmp_ge_u32 s41, 30
  s_cbranch_scc1 K_fin
  v_and_b32 v100, 63, v166
  v_lshrrev_b32 v101, 4, v100
  v_and_b32 v102, 15, v100
  v_and_b32 v103, 31, v100
  v_lshrrev_b32 v104, 5, v100
  v_lshrrev_b32 v105, 2, v102
  v_and_b32 v106, 3, v100
  v_and_b32 v107, 1, v106
  v_lshlrev_b32 v107, 1, v107
  v_lshrrev_b32 v109, 1, v106
  v_or_b32 v107, v107, v109
  v_lshlrev_b32 v107, 3, v107
  v_and_b32 v109, 1, v101
  v_lshlrev_b32 v109, 5, v109
  v_add_u32 v107, v107, v109
  v_lshlrev_b32 v108, 2, v101
  v_xor_b32 v108, v108, v102
  v_lshlrev_b32 v108, 4, v108
  s_lshr_b32 s37, s40, 1
  s_and_b32 s42, s40, 1
  s_mul_i32 s43, s41, 52
  s_lshr_b32 s43, s43, 8
  s_mul_i32 s45, s43, 5
  s_sub_u32 s38, s41, s45
  s_mul_i32 s45, s42, 6
  s_add_u32 s39, s45, s43
  v_mov_b32 v99, v167
  s_cmp_lt_u32 s36, 4
  s_cbranch_scc1 K_pc_cons
  s_sub_u32 s55, s36, 4
  s_lshl_b32 s56, s39, 2
  s_add_u32 s56, s56, s55
  s_lshl_b32 s56, s56, 8
  s_lshl_b32 s57, s37, 6
  s_add_u32 s56, s56, s57
  s_lshl_b32 s56, s56, 10
  s_lshl_b32 s57, s55, 2
  v_add_u32 v21, s57, v101
  s_movk_i32 s57, 1280
  v_mul_lo_u32 v21, v21, s57
  v_add_u32 v21, v21, v108
  s_mul_i32 s57, s37, 1310720
  s_lshl_b32 s58, s38, 8
  s_add_u32 s57, s57, s58
  s_lshl_b32 s58, s55, 11
  s_lshl_b32 s59, s55, 10
  s_mul_i32 s46, s38, 0
  s_add_u32 s47, s46, 0
  s_and_b32 s47, s47, 31
  s_mul_i32 s47, s47, 40960
  s_add_u32 s47, s47, s57
  s_add_u32 s53, s47, 0
  s_add_u32 s54, s59, 81920
  s_mov_b32 m0, s54
  s_nop 0
  buffer_load_dwordx4 v21, s[4:7], s53 offen lds
  s_add_u32 s53, s47, 20480
  s_add_u32 s54, s59, 86016
  s_mov_b32 m0, s54
  s_nop 0
  buffer_load_dwordx4 v21, s[4:7], s53 offen lds
  s_add_u32 s47, s46, 1
  s_and_b32 s47, s47, 31
  s_mul_i32 s47, s47, 40960
  s_add_u32 s47, s47, s57
  s_add_u32 s53, s47, 0
  s_add_u32 s54, s59, 90112
  s_mov_b32 m0, s54
  s_nop 0
  buffer_load_dwordx4 v21, s[4:7], s53 offen lds
  s_add_u32 s53, s47, 20480
  s_add_u32 s54, s59, 94208
  s_mov_b32 m0, s54
  s_nop 0
  buffer_load_dwordx4 v21, s[4:7], s53 offen lds
  s_add_u32 s47, s46, 2
  s_and_b32 s47, s47, 31
  s_mul_i32 s47, s47, 40960
  s_add_u32 s47, s47, s57
  s_add_u32 s53, s47, 0
  s_add_u32 s54, s59, 98304
  s_mov_b32 m0, s54
  s_nop 0
  buffer_load_dwordx4 v21, s[4:7], s53 offen lds
  s_add_u32 s53, s47, 20480
  s_add_u32 s54, s59, 102400
  s_mov_b32 m0, s54
  s_nop 0
  buffer_load_dwordx4 v21, s[4:7], s53 offen lds
  s_add_u32 s47, s46, 3
  s_and_b32 s47, s47, 31
  s_mul_i32 s47, s47, 40960
  s_add_u32 s47, s47, s57
  s_add_u32 s53, s47, 0
  s_add_u32 s54, s59, 106496
  s_mov_b32 m0, s54
  s_nop 0
  buffer_load_dwordx4 v21, s[4:7], s53 offen lds
  s_add_u32 s53, s47, 20480
  s_add_u32 s54, s59, 110592
  s_mov_b32 m0, s54
  s_nop 0
  buffer_load_dwordx4 v21, s[4:7], s53 offen lds
  s_add_u32 s47, s46, 4
  s_and_b32 s47, s47, 31
  s_mul_i32 s47, s47, 40960
  s_add_u32 s47, s47, s57
  s_add_u32 s53, s47, 0
  s_add_u32 s54, s59, 114688
  s_mov_b32 m0, s54
  s_nop 0
  buffer_load_dwordx4 v21, s[4:7], s53 offen lds
  s_add_u32 s53, s47, 20480
  s_add_u32 s54, s59, 118784
  s_mov_b32 m0, s54
  s_nop 0
  buffer_load_dwordx4 v21, s[4:7], s53 offen lds
  s_add_u32 s47, s46, 5
  s_and_b32 s47, s47, 31
  s_mul_i32 s47, s47, 40960
  s_add_u32 s47, s47, s57
  s_add_u32 s53, s47, 0
  s_add_u32 s54, s59, 122880
  s_mov_b32 m0, s54
  s_nop 0
  buffer_load_dwordx4 v21, s[4:7], s53 offen lds
  s_add_u32 s53, s47, 20480
  s_add_u32 s54, s59, 126976
  s_mov_b32 m0, s54
  s_nop 0
  buffer_load_dwordx4 v21, s[4:7], s53 offen lds
  s_add_u32 s47, s46, 6
  s_and_b32 s47, s47, 31
  s_mul_i32 s47, s47, 40960
  s_add_u32 s47, s47, s57
  s_add_u32 s53, s47, 0
  s_add_u32 s54, s59, 131072
  s_mov_b32 m0, s54
  s_nop 0
  buffer_load_dwordx4 v21, s[4:7], s53 offen lds
  s_add_u32 s53, s47, 20480
  s_add_u32 s54, s59, 135168
  s_mov_b32 m0, s54
  s_nop 0
  buffer_load_dwordx4 v21, s[4:7], s53 offen lds
  s_add_u32 s47, s46, 7
  s_and_b32 s47, s47, 31
  s_mul_i32 s47, s47, 40960
  s_add_u32 s47, s47, s57
  s_add_u32 s53, s47, 0
  s_add_u32 s54, s59, 139264
  s_mov_b32 m0, s54
  s_nop 0
  buffer_load_dwordx4 v21, s[4:7], s53 offen lds
  s_add_u32 s53, s47, 20480
  s_add_u32 s54, s59, 143360
  s_mov_b32 m0, s54
  s_nop 0
  buffer_load_dwordx4 v21, s[4:7], s53 offen lds
  s_add_u32 s47, s46, 8
  s_and_b32 s47, s47, 31
  s_mul_i32 s47, s47, 40960
  s_add_u32 s47, s47, s57
  s_add_u32 s53, s47, 0
  s_add_u32 s54, s59, 147456
  s_mov_b32 m0, s54
  s_nop 0
  buffer_load_dwordx4 v21, s[4:7], s53 offen lds
  s_add_u32 s53, s47, 20480
  s_add_u32 s54, s59, 151552
  s_mov_b32 m0, s54
  s_nop 0
  buffer_load_dwordx4 v21, s[4:7], s53 offen lds
  s_add_u32 s47, s46, 9
  s_and_b32 s47, s47, 31
  s_mul_i32 s47, s47, 40960
  s_add_u32 s47, s47, s57
  s_add_u32 s53, s47, 0
  s_add_u32 s54, s59, 155648
  s_mov_b32 m0, s54
  s_nop 0
  buffer_load_dwordx4 v21, s[4:7], s53 offen lds
  s_add_u32 s53, s47, 20480
  s_add_u32 s54, s59, 159744
  s_mov_b32 m0, s54
  s_nop 0
  buffer_load_dwordx4 v21, s[4:7], s53 offen lds
  s_cmp_eq_u32 s36, 4
  s_cbranch_scc0 K_poll1_ok
  s_lshl_b32 s60, s39, 2
  s_add_u32 s63, s60, 3
  s_mul_i32 s60, s60, 43
  s_lshr_b32 s60, s60, 8
  s_lshl_b32 s60, s60, 2
  s_add_u32 s60, s60, s37
  s_lshl_b32 s60, s60, 8
  s_add_u32 s60, s60, 50331648
  s_mul_i32 s63, s63, 43
  s_lshr_b32 s63, s63, 8
  s_lshl_b32 s63, s63, 2
  s_add_u32 s63, s63, s37
  s_lshl_b32 s63, s63, 8
  s_add_u32 s63, s63, 50331648
  s_mov_b32 s61, 0
K_poll1:
  buffer_load_dword v22, off, s[32:35], s60 sc1
  buffer_load_dword v23, off, s[32:35], s63 sc1
  s_waitcnt vmcnt(0)
  v_min_u32 v22, v22, v23
  s_nop 0
  v_readfirstlane_b32 s62, v22
  s_add_u32 s61, s61, 1
  s_cmp_ge_u32 s62, 8
  s_cbranch_scc1 K_poll1_ok
  s_cmp_ge_u32 s61, 20000
  s_cbranch_scc1 K_poll1_ok
  s_sleep 8
  s_branch K_poll1
K_poll1_ok:
  s_waitcnt vmcnt(0)
  s_barrier
  s_add_u32 s53, s46, 0
  s_and_b32 s53, s53, 31
  s_lshl_b32 s53, s53, 11
  s_add_u32 s53, s53, s56
  s_add_u32 s54, s58, 0
  s_mov_b32 m0, s54
  s_nop 0
  buffer_load_dwordx4 v99, s[32:35], s53 offen sc1 lds
  buffer_load_dwordx4 v99, s[32:35], s53 offen offset:1024 sc1 lds
  s_add_u32 s53, s46, 1
  s_and_b32 s53, s53, 31
  s_lshl_b32 s53, s53, 11
  s_add_u32 s53, s53, s56
  s_add_u32 s54, s58, 8192
  s_mov_b32 m0, s54
  s_nop 0
  buffer_load_dwordx4 v99, s[32:35], s53 offen sc1 lds
  buffer_load_dwordx4 v99, s[32:35], s53 offen offset:1024 sc1 lds
  s_add_u32 s53, s46, 2
  s_and_b32 s53, s53, 31
  s_lshl_b32 s53, s53, 11
  s_add_u32 s53, s53, s56
  s_add_u32 s54, s58, 16384
  s_mov_b32 m0, s54
  s_nop 0
  buffer_load_dwordx4 v99, s[32:35], s53 offen sc1 lds
  buffer_load_dwordx4 v99, s[32:35], s53 offen offset:1024 sc1 lds
  s_add_u32 s53, s46, 3
  s_and_b32 s53, s53, 31
  s_lshl_b32 s53, s53, 11
  s_add_u32 s53, s53, s56
  s_add_u32 s54, s58, 24576
  s_mov_b32 m0, s54
  s_nop 0
  buffer_load_dwordx4 v99, s[32:35], s53 offen sc1 lds
  buffer_load_dwordx4 v99, s[32:35], s53 offen offset:1024 sc1 lds
  s_waitcnt vmcnt(4)
  s_barrier
  s_add_u32 s53, s46, 4
  s_and_b32 s53, s53, 31
  s_lshl_b32 s53, s53, 11
  s_add_u32 s53, s53, s56
  s_add_u32 s54, s58, 32768
  s_mov_b32 m0, s54
  s_nop 0
  buffer_load_dwordx4 v99, s[32:35], s53 offen sc1 lds
  buffer_load_dwordx4 v99, s[32:35], s53 offen offset:1024 sc1 lds
  s_add_u32 s53, s46, 5
  s_and_b32 s53, s53, 31
  s_lshl_b32 s53, s53, 11
  s_add_u32 s53, s53, s56
  s_add_u32 s54, s58, 40960
  s_mov_b32 m0, s54
  s_nop 0
  buffer_load_dwordx4 v99, s[32:35], s53 offen sc1 lds
  buffer_load_dwordx4 v99, s[32:35], s53 offen offset:1024 sc1 lds
  s_add_u32 s53, s46, 6
  s_and_b32 s53, s53, 31
  s_lshl_b32 s53, s53, 11
  s_add_u32 s53, s53, s56
  s_add_u32 s54, s58, 49152
  s_mov_b32 m0, s54
  s_nop 0
  buffer_load_dwordx4 v99, s[32:35], s53 offen sc1 lds
  buffer_load_dwordx4 v99, s[32:35], s53 offen offset:1024 sc1 lds
  s_add_u32 s53, s46, 7
  s_and_b32 s53, s53, 31
  s_lshl_b32 s53, s53, 11
  s_add_u32 s53, s53, s56
  s_add_u32 s54, s58, 57344
  s_mov_b32 m0, s54
  s_nop 0
  buffer_load_dwordx4 v99, s[32:35], s53 offen sc1 lds
  buffer_load_dwordx4 v99, s[32:35], s53 offen offset:1024 sc1 lds
  s_waitcnt vmcnt(8)
  s_barrier
  s_add_u32 s53, s46, 8
  s_and_b32 s53, s53, 31
  s_lshl_b32 s53, s53, 11
  s_add_u32 s53, s53, s56
  s_add_u32 s54, s58, 65536
  s_mov_b32 m0, s54
  s_nop 0
  buffer_load_dwordx4 v99, s[32:35], s53 offen sc1 lds
  buffer_load_dwordx4 v99, s[32:35], s53 offen offset:1024 sc1 lds
  s_add_u32 s53, s46, 9
  s_and_b32 s53, s53, 31
  s_lshl_b32 s53, s53, 11
  s_add_u32 s53, s53, s56
  s_add_u32 s54, s58, 73728
  s_mov_b32 m0, s54
  s_nop 0
  buffer_load_dwordx4 v99, s[32:35], s53 offen sc1 lds
  buffer_load_dwordx4 v99, s[32:35], s53 offen offset:1024 sc1 lds
  s_add_u32 s53, s46, 10
  s_and_b32 s53, s53, 31
  s_lshl_b32 s53, s53, 11
  s_add_u32 s53, s53, s56
  s_add_u32 s54, s58, 0
  s_mov_b32 m0, s54
  s_nop 0
  buffer_load_dwordx4 v99, s[32:35], s53 offen sc1 lds
  buffer_load_dwordx4 v99, s[32:35], s53 offen offset:1024 sc1 lds
  s_add_u32 s47, s46, 10
  s_and_b32 s47, s47, 31
  s_mul_i32 s47, s47, 40960
  s_add_u32 s47, s47, s57
  s_add_u32 s53, s47, 0
  s_add_u32 s54, s59, 81920
  s_mov_b32 m0, s54
  s_nop 0
  buffer_load_dwordx4 v21, s[4:7], s53 offen lds
  s_add_u32 s53, s47, 20480
  s_add_u32 s54, s59, 86016
  s_mov_b32 m0, s54
  s_nop 0
  buffer_load_dwordx4 v21, s[4:7], s53 offen lds
  s_waitcnt vmcnt(12)
  s_barrier
  s_add_u32 s53, s46, 11
  s_and_b32 s53, s53, 31
  s_lshl_b32 s53, s53, 11
  s_add_u32 s53, s53, s56
  s_add_u32 s54, s58, 8192
  s_mov_b32 m0, s54
  s_nop 0
  buffer_load_dwordx4 v99, s[32:35], s53 offen sc1 lds
  buffer_load_dwordx4 v99, s[32:35], s53 offen offset:1024 sc1 lds
  s_add_u32 s53, s46, 12
  s_and_b32 s53, s53, 31
  s_lshl_b32 s53, s53, 11
  s_add_u32 s53, s53, s56
  s_add_u32 s54, s58, 16384
  s_mov_b32 m0, s54
  s_nop 0
  buffer_load_dwordx4 v99, s[32:35], s53 offen sc1 lds
  buffer_load_dwordx4 v99, s[32:35], s53 offen offset:1024 sc1 lds
  s_add_u32 s47, s46, 11
  s_and_b32 s47, s47, 31
  s_mul_i32 s47, s47, 40960
  s_add_u32 s47, s47, s57
  s_add_u32 s53, s47, 0
  s_add_u32 s54, s59, 90112
  s_mov_b32 m0, s54
  s_nop 0
  buffer_load_dwordx4 v21, s[4:7], s53 offen lds
  s_add_u32 s53, s47, 20480
  s_add_u32 s54, s59, 94208
  s_mov_b32 m0, s54
  s_nop 0
  buffer_load_dwordx4 v21, s[4:7], s53 offen lds
  s_add_u32 s47, s46, 12
  s_and_b32 s47, s47, 31
  s_mul_i32 s47, s47, 40960
  s_add_u32 s47, s47, s57
  s_add_u32 s53, s47, 0
  s_add_u32 s54, s59, 98304
  s_mov_b32 m0, s54
  s_nop 0
  buffer_load_dwordx4 v21, s[4:7], s53 offen lds
  s_add_u32 s53, s47, 20480
  s_add_u32 s54, s59, 102400
  s_mov_b32 m0, s54
  s_nop 0
  buffer_load_dwordx4 v21, s[4:7], s53 offen lds
  s_waitcnt vmcnt(16)
  s_barrier
  s_add_u32 s53, s46, 13
  s_and_b32 s53, s53, 31
  s_lshl_b32 s53, s53, 11
  s_add_u32 s53, s53, s56
  s_add_u32 s54, s58, 24576
  s_mov_b32 m0, s54
  s_nop 0
  buffer_load_dwordx4 v99, s[32:35], s53 offen sc1 lds
  buffer_load_dwordx4 v99, s[32:35], s53 offen offset:1024 sc1 lds
  s_add_u32 s53, s46, 14
  s_and_b32 s53, s53, 31
  s_lshl_b32 s53, s53, 11
  s_add_u32 s53, s53, s56
  s_add_u32 s54, s58, 32768
  s_mov_b32 m0, s54
  s_nop 0
  buffer_load_dwordx4 v99, s[32:35], s53 offen sc1 lds
  buffer_load_dwordx4 v99, s[32:35], s53 offen offset:1024 sc1 lds
  s_add_u32 s47, s46, 13
  s_and_b32 s47, s47, 31
  s_mul_i32 s47, s47, 40960
  s_add_u32 s47, s47, s57
  s_add_u32 s53, s47, 0
  s_add_u32 s54, s59, 106496
  s_mov_b32 m0, s54
  s_nop 0
  buffer_load_dwordx4 v21, s[4:7], s53 offen lds
  s_add_u32 s53, s47, 20480
  s_add_u32 s54, s59, 110592
  s_mov_b32 m0, s54
  s_nop 0
  buffer_load_dwordx4 v21, s[4:7], s53 offen lds
  s_add_u32 s47, s46, 14
  s_and_b32 s47, s47, 31
  s_mul_i32 s47, s47, 40960
  s_add_u32 s47, s47, s57
  s_add_u32 s53, s47, 0
  s_add_u32 s54, s59, 114688
  s_mov_b32 m0, s54
  s_nop 0
  buffer_load_dwordx4 v21, s[4:7], s53 offen lds
  s_add_u32 s53, s47, 20480
  s_add_u32 s54, s59, 118784
  s_mov_b32 m0, s54
  s_nop 0
  buffer_load_dwordx4 v21, s[4:7], s53 offen lds
  s_waitcnt vmcnt(20)
  s_barrier
  s_add_u32 s53, s46, 15
  s_and_b32 s53, s53, 31
  s_lshl_b32 s53, s53, 11
  s_add_u32 s53, s53, s56
  s_add_u32 s54, s58, 40960
  s_mov_b32 m0, s54
  s_nop 0
  buffer_load_dwordx4 v99, s[32:35], s53 offen sc1 lds
  buffer_load_dwordx4 v99, s[32:35], s53 offen offset:1024 sc1 lds
  s_add_u32 s53, s46, 16
  s_and_b32 s53, s53, 31
  s_lshl_b32 s53, s53, 11
  s_add_u32 s53, s53, s56
  s_add_u32 s54, s58, 49152
  s_mov_b32 m0, s54
  s_nop 0
  buffer_load_dwordx4 v99, s[32:35], s53 offen sc1 lds
  buffer_load_dwordx4 v99, s[32:35], s53 offen offset:1024 sc1 lds
  s_add_u32 s47, s46, 15
  s_and_b32 s47, s47, 31
  s_mul_i32 s47, s47, 40960
  s_add_u32 s47, s47, s57
  s_add_u32 s53, s47, 0
  s_add_u32 s54, s59, 122880
  s_mov_b32 m0, s54
  s_nop 0
  buffer_load_dwordx4 v21, s[4:7], s53 offen lds
  s_add_u32 s53, s47, 20480
  s_add_u32 s54, s59, 126976
  s_mov_b32 m0, s54
  s_nop 0
  buffer_load_dwordx4 v21, s[4:7], s53 offen lds
  s_add_u32 s47, s46, 16
  s_and_b32 s47, s47, 31
  s_mul_i32 s47, s47, 40960
  s_add_u32 s47, s47, s57
  s_add_u32 s53, s47, 0
  s_add_u32 s54, s59, 131072
  s_mov_b32 m0, s54
  s_nop 0
  buffer_load_dwordx4 v21, s[4:7], s53 offen lds
  s_add_u32 s53, s47, 20480
  s_add_u32 s54, s59, 135168
  s_mov_b32 m0, s54
  s_nop 0
  buffer_load_dwordx4 v21, s[4:7], s53 offen lds
  s_waitcnt vmcnt(18)
  s_barrier
  s_add_u32 s53, s46, 17
  s_and_b32 s53, s53, 31
  s_lshl_b32 s53, s53, 11
  s_add_u32 s53, s53, s56
  s_add_u32 s54, s58, 57344
  s_mov_b32 m0, s54
  s_nop 0
  buffer_load_dwordx4 v99, s[32:35], s53 offen sc1 lds
  buffer_load_dwordx4 v99, s[32:35], s53 offen offset:1024 sc1 lds
  s_add_u32 s53, s46, 18
  s_and_b32 s53, s53, 31
  s_lshl_b32 s53, s53, 11
  s_add_u32 s53, s53, s56
  s_add_u32 s54, s58, 65536
  s_mov_b32 m0, s54
  s_nop 0
  buffer_load_dwordx4 v99, s[32:35], s53 offen sc1 lds
  buffer_load_dwordx4 v99, s[32:35], s53 offen offset:1024 sc1 lds
  s_add_u32 s47, s46, 17
  s_and_b32 s47, s47, 31
  s_mul_i32 s47, s47, 40960
  s_add_u32 s47, s47, s57
  s_add_u32 s53, s47, 0
  s_add_u32 s54, s59, 139264
  s_mov_b32 m0, s54
  s_nop 0
  buffer_load_dwordx4 v21, s[4:7], s53 offen lds
  s_add_u32 s53, s47, 20480
  s_add_u32 s54, s59, 143360
  s_mov_b32 m0, s54
  s_nop 0
  buffer_load_dwordx4 v21, s[4:7], s53 offen lds
  s_add_u32 s47, s46, 18
  s_and_b32 s47, s47, 31
  s_mul_i32 s47, s47, 40960
  s_add_u32 s47, s47, s57
  s_add_u32 s53, s47, 0
  s_add_u32 s54, s59, 147456
  s_mov_b32 m0, s54
  s_nop 0
  buffer_load_dwordx4 v21, s[4:7], s53 offen lds
  s_add_u32 s53, s47, 20480
  s_add_u32 s54, s59, 151552
  s_mov_b32 m0, s54
  s_nop 0
  buffer_load_dwordx4 v21, s[4:7], s53 offen lds
  s_waitcnt vmcnt(18)
  s_barrier
  s_add_u32 s53, s46, 19
  s_and_b32 s53, s53, 31
  s_lshl_b32 s53, s53, 11
  s_add_u32 s53, s53, s56
  s_add_u32 s54, s58, 73728
  s_mov_b32 m0, s54
  s_nop 0
  buffer_load_dwordx4 v99, s[32:35], s53 offen sc1 lds
  buffer_load_dwordx4 v99, s[32:35], s53 offen offset:1024 sc1 lds
  s_add_u32 s53, s46, 20
  s_and_b32 s53, s53, 31
  s_lshl_b32 s53, s53, 11
  s_add_u32 s53, s53, s56
  s_add_u32 s54, s58, 0
  s_mov_b32 m0, s54
  s_nop 0
  buffer_load_dwordx4 v99, s[32:35], s53 offen sc1 lds
  buffer_load_dwordx4 v99, s[32:35], s53 offen offset:1024 sc1 lds
  s_add_u32 s47, s46, 19
  s_and_b32 s47, s47, 31
  s_mul_i32 s47, s47, 40960
  s_add_u32 s47, s47, s57
  s_add_u32 s53, s47, 0
  s_add_u32 s54, s59, 155648
  s_mov_b32 m0, s54
  s_nop 0
  buffer_load_dwordx4 v21, s[4:7], s53 offen lds
  s_add_u32 s53, s47, 20480
  s_add_u32 s54, s59, 159744
  s_mov_b32 m0, s54
  s_nop 0
  buffer_load_dwordx4 v21, s[4:7], s53 offen lds
  s_add_u32 s47, s46, 20
  s_and_b32 s47, s47, 31
  s_mul_i32 s47, s47, 40960
  s_add_u32 s47, s47, s57
  s_add_u32 s53, s47, 0
  s_add_u32 s54, s59, 81920
  s_mov_b32 m0, s54
  s_nop 0
  buffer_load_dwordx4 v21, s[4:7], s53 offen lds
  s_add_u32 s53, s47, 20480
  s_add_u32 s54, s59, 86016
  s_mov_b32 m0, s54
  s_nop 0
  buffer_load_dwordx4 v21, s[4:7], s53 offen lds
  s_waitcnt vmcnt(18)
  s_barrier
  s_add_u32 s53, s46, 21
  s_and_b32 s53, s53, 31
  s_lshl_b32 s53, s53, 11
  s_add_u32 s53, s53, s56
  s_add_u32 s54, s58, 8192
  s_mov_b32 m0, s54
  s_nop 0
  buffer_load_dwordx4 v99, s[32:35], s53 offen sc1 lds
  buffer_load_dwordx4 v99, s[32:35], s53 offen offset:1024 sc1 lds
  s_add_u32 s53, s46, 22
  s_and_b32 s53, s53, 31
  s_lshl_b32 s53, s53, 11
  s_add_u32 s53, s53, s56
  s_add_u32 s54, s58, 16384
  s_mov_b32 m0, s54
  s_nop 0
  buffer_load_dwordx4 v99, s[32:35], s53 offen sc1 lds
  buffer_load_dwordx4 v99, s[32:35], s53 offen offset:1024 sc1 lds
  s_add_u32 s47, s46, 21
  s_and_b32 s47, s47, 31
  s_mul_i32 s47, s47, 40960
  s_add_u32 s47, s47, s57
  s_add_u32 s53, s47, 0
  s_add_u32 s54, s59, 90112
  s_mov_b32 m0, s54
  s_nop 0
  buffer_load_dwordx4 v21, s[4:7], s53 offen lds
  s_add_u32 s53, s47, 20480
  s_add_u32 s54, s59, 94208
  s_mov_b32 m0, s54
  s_nop 0
  buffer_load_dwordx4 v21, s[4:7], s53 offen lds
  s_add_u32 s47, s46, 22
  s_and_b32 s47, s47, 31
  s_mul_i32 s47, s47, 40960
  s_add_u32 s47, s47, s57
  s_add_u32 s53, s47, 0
  s_add_u32 s54, s59, 98304
  s_mov_b32 m0, s54
  s_nop 0
  buffer_load_dwordx4 v21, s[4:7], s53 offen lds
  s_add_u32 s53, s47, 20480
  s_add_u32 s54, s59, 102400
  s_mov_b32 m0, s54
  s_nop 0
  buffer_load_dwordx4 v21, s[4:7], s53 offen lds
  s_waitcnt vmcnt(18)
  s_barrier
  s_add_u32 s53, s46, 23
  s_and_b32 s53, s53, 31
  s_lshl_b32 s53, s53, 11
  s_add_u32 s53, s53, s56
  s_add_u32 s54, s58, 24576
  s_mov_b32 m0, s54
  s_nop 0
  buffer_load_dwordx4 v99, s[32:35], s53 offen sc1 lds
  buffer_load_dwordx4 v99, s[32:35], s53 offen offset:1024 sc1 lds
  s_add_u32 s53, s46, 24
  s_and_b32 s53, s53, 31
  s_lshl_b32 s53, s53, 11
  s_add_u32 s53, s53, s56
  s_add_u32 s54, s58, 32768
  s_mov_b32 m0, s54
  s_nop 0
  buffer_load_dwordx4 v99, s[32:35], s53 offen sc1 lds
  buffer_load_dwordx4 v99, s[32:35], s53 offen offset:1024 sc1 lds
  s_add_u32 s47, s46, 23
  s_and_b32 s47, s47, 31
  s_mul_i32 s47, s47, 40960
  s_add_u32 s47, s47, s57
  s_add_u32 s53, s47, 0
  s_add_u32 s54, s59, 106496
  s_mov_b32 m0, s54
  s_nop 0
  buffer_load_dwordx4 v21, s[4:7], s53 offen lds
  s_add_u32 s53, s47, 20480
  s_add_u32 s54, s59, 110592
  s_mov_b32 m0, s54
  s_nop 0
  buffer_load_dwordx4 v21, s[4:7], s53 offen lds
  s_add_u32 s47, s46, 24
  s_and_b32 s47, s47, 31
  s_mul_i32 s47, s47, 40960
  s_add_u32 s47, s47, s57
  s_add_u32 s53, s47, 0
  s_add_u32 s54, s59, 114688
  s_mov_b32 m0, s54
  s_nop 0
  buffer_load_dwordx4 v21, s[4:7], s53 offen lds
  s_add_u32 s53, s47, 20480
  s_add_u32 s54, s59, 118784
  s_mov_b32 m0, s54
  s_nop 0
  buffer_load_dwordx4 v21, s[4:7], s53 offen lds
  s_waitcnt vmcnt(18)
  s_barrier
  s_add_u32 s53, s46, 25
  s_and_b32 s53, s53, 31
  s_lshl_b32 s53, s53, 11
  s_add_u32 s53, s53, s56
  s_add_u32 s54, s58, 40960
  s_mov_b32 m0, s54
  s_nop 0
  buffer_load_dwordx4 v99, s[32:35], s53 offen sc1 lds
  buffer_load_dwordx4 v99, s[32:35], s53 offen offset:1024 sc1 lds
  s_add_u32 s53, s46, 26
  s_and_b32 s53, s53, 31
  s_lshl_b32 s53, s53, 11
  s_add_u32 s53, s53, s56
  s_add_u32 s54, s58, 49152
  s_mov_b32 m0, s54
  s_nop 0
  buffer_load_dwordx4 v99, s[32:35], s53 offen sc1 lds
  buffer_load_dwordx4 v99, s[32:35], s53 offen offset:1024 sc1 lds
  s_add_u32 s47, s46, 25
  s_and_b32 s47, s47, 31
  s_mul_i32 s47, s47, 40960
  s_add_u32 s47, s47, s57
  s_add_u32 s53, s47, 0
  s_add_u32 s54, s59, 122880
  s_mov_b32 m0, s54
  s_nop 0
  buffer_load_dwordx4 v21, s[4:7], s53 offen lds
  s_add_u32 s53, s47, 20480
  s_add_u32 s54, s59, 126976
  s_mov_b32 m0, s54
  s_nop 0
  buffer_load_dwordx4 v21, s[4:7], s53 offen lds
  s_add_u32 s47, s46, 26
  s_and_b32 s47, s47, 31
  s_mul_i32 s47, s47, 40960
  s_add_u32 s47, s47, s57
  s_add_u32 s53, s47, 0
  s_add_u32 s54, s59, 131072
  s_mov_b32 m0, s54
  s_nop 0
  buffer_load_dwordx4 v21, s[4:7], s53 offen lds
  s_add_u32 s53, s47, 20480
  s_add_u32 s54, s59, 135168
  s_mov_b32 m0, s54
  s_nop 0
  buffer_load_dwordx4 v21, s[4:7], s53 offen lds
  s_waitcnt vmcnt(18)
  s_barrier
  s_add_u32 s53, s46, 27
  s_and_b32 s53, s53, 31
  s_lshl_b32 s53, s53, 11
  s_add_u32 s53, s53, s56
  s_add_u32 s54, s58, 57344
  s_mov_b32 m0, s54
  s_nop 0
  buffer_load_dwordx4 v99, s[32:35], s53 offen sc1 lds
  buffer_load_dwordx4 v99, s[32:35], s53 offen offset:1024 sc1 lds
  s_add_u32 s53, s46, 28
  s_and_b32 s53, s53, 31
  s_lshl_b32 s53, s53, 11
  s_add_u32 s53, s53, s56
  s_add_u32 s54, s58, 65536
  s_mov_b32 m0, s54
  s_nop 0
  buffer_load_dwordx4 v99, s[32:35], s53 offen sc1 lds
  buffer_load_dwordx4 v99, s[32:35], s53 offen offset:1024 sc1 lds
  s_add_u32 s47, s46, 27
  s_and_b32 s47, s47, 31
  s_mul_i32 s47, s47, 40960
  s_add_u32 s47, s47, s57
  s_add_u32 s53, s47, 0
  s_add_u32 s54, s59, 139264
  s_mov_b32 m0, s54
  s_nop 0
  buffer_load_dwordx4 v21, s[4:7], s53 offen lds
  s_add_u32 s53, s47, 20480
  s_add_u32 s54, s59, 143360
  s_mov_b32 m0, s54
  s_nop 0
  buffer_load_dwordx4 v21, s[4:7], s53 offen lds
  s_add_u32 s47, s46, 28
  s_and_b32 s47, s47, 31
  s_mul_i32 s47, s47, 40960
  s_add_u32 s47, s47, s57
  s_add_u32 s53, s47, 0
  s_add_u32 s54, s59, 147456
  s_mov_b32 m0, s54
  s_nop 0
  buffer_load_dwordx4 v21, s[4:7], s53 offen lds
  s_add_u32 s53, s47, 20480
  s_add_u32 s54, s59, 151552
  s_mov_b32 m0, s54
  s_nop 0
  buffer_load_dwordx4 v21, s[4:7], s53 offen lds
  s_waitcnt vmcnt(18)
  s_barrier
  s_add_u32 s53, s46, 29
  s_and_b32 s53, s53, 31
  s_lshl_b32 s53, s53, 11
  s_add_u32 s53, s53, s56
  s_add_u32 s54, s58, 73728
  s_mov_b32 m0, s54
  s_nop 0
  buffer_load_dwordx4 v99, s[32:35], s53 offen sc1 lds
  buffer_load_dwordx4 v99, s[32:35], s53 offen offset:1024 sc1 lds
  s_add_u32 s53, s46, 30
  s_and_b32 s53, s53, 31
  s_lshl_b32 s53, s53, 11
  s_add_u32 s53, s53, s56
  s_add_u32 s54, s58, 0
  s_mov_b32 m0, s54
  s_nop 0
  buffer_load_dwordx4 v99, s[32:35], s53 offen sc1 lds
  buffer_load_dwordx4 v99, s[32:35], s53 offen offset:1024 sc1 lds
  s_add_u32 s47, s46, 29
  s_and_b32 s47, s47, 31
  s_mul_i32 s47, s47, 40960
  s_add_u32 s47, s47, s57
  s_add_u32 s53, s47, 0
  s_add_u32 s54, s59, 155648
  s_mov_b32 m0, s54
  s_nop 0
  buffer_load_dwordx4 v21, s[4:7], s53 offen lds
  s_add_u32 s53, s47, 20480
  s_add_u32 s54, s59, 159744
  s_mov_b32 m0, s54
  s_nop 0
  buffer_load_dwordx4 v21, s[4:7], s53 offen lds
  s_add_u32 s47, s46, 30
  s_and_b32 s47, s47, 31
  s_mul_i32 s47, s47, 40960
  s_add_u32 s47, s47, s57
  s_add_u32 s53, s47, 0
  s_add_u32 s54, s59, 81920
  s_mov_b32 m0, s54
  s_nop 0
  buffer_load_dwordx4 v21, s[4:7], s53 offen lds
  s_add_u32 s53, s47, 20480
  s_add_u32 s54, s59, 86016
  s_mov_b32 m0, s54
  s_nop 0
  buffer_load_dwordx4 v21, s[4:7], s53 offen lds
  s_waitcnt vmcnt(18)
  s_barrier
  s_add_u32 s53, s46, 31
  s_and_b32 s53, s53, 31
  s_lshl_b32 s53, s53, 11
  s_add_u32 s53, s53, s56
  s_add_u32 s54, s58, 8192
  s_mov_b32 m0, s54
  s_nop 0
  buffer_load_dwordx4 v99, s[32:35], s53 offen sc1 lds
  buffer_load_dwordx4 v99, s[32:35], s53 offen offset:1024 sc1 lds
  s_add_u32 s47, s46, 31
  s_and_b32 s47, s47, 31
  s_mul_i32 s47, s47, 40960
  s_add_u32 s47, s47, s57
  s_add_u32 s53, s47, 0
  s_add_u32 s54, s59, 90112
  s_mov_b32 m0, s54
  s_nop 0
  buffer_load_dwordx4 v21, s[4:7], s53 offen lds
  s_add_u32 s53, s47, 20480
  s_add_u32 s54, s59, 94208
  s_mov_b32 m0, s54
  s_nop 0
  buffer_load_dwordx4 v21, s[4:7], s53 offen lds
  s_waitcnt vmcnt(14)
  s_barrier
  s_waitcnt vmcnt(6)
  s_barrier
  s_waitcnt vmcnt(0)
  s_barrier
  s_branch K_fin
K_pc_cons:
  s_lshr_b32 s48, s36, 1
  s_and_b32 s49, s36, 1
  s_lshl_b32 s55, s48, 12
  v_add_u32 v96, s55, v99
  v_lshlrev_b32 v94, 3, v104
  v_add_u32 v94, v94, v105
  v_lshlrev_b32 v94, 8, v94
  s_lshl_b32 s52, s49, 1
  v_xor_b32 v95, s52, v105
  v_lshlrev_b32 v95, 6, v95
  v_add3_u32 v94, v94, v95, v107
  v_add_u32 v97, 81920, v94
  v_xor_b32 v98, 64, v97
  v_add_u32 v110, 40960, v97
  v_add_u32 v111, 40960, v98
  v_add_u32 v128, 40960, v96
  s_barrier
  s_barrier
  ds_read_b64_tr_b16 v[64:65], v97 offset:0
  ds_read_b64_tr_b16 v[66:67], v97 offset:1024
  ds_read_b64_tr_b16 v[68:69], v98 offset:0
  ds_read_b64_tr_b16 v[70:71], v98 offset:1024
  ds_read_b128 v[72:75], v96 offset:0
  ds_read_b128 v[76:79], v96 offset:2048
  ds_read_b64_tr_b16 v[80:81], v97 offset:4096
  ds_read_b64_tr_b16 v[82:83], v97 offset:5120
  ds_read_b64_tr_b16 v[84:85], v98 offset:4096
  ds_read_b64_tr_b16 v[86:87], v98 offset:5120
  ds_read_b128 v[88:91], v96 offset:1024
  ds_read_b128 v[92:95], v96 offset:3072
  ds_read_b64_tr_b16 v[132:133], v97 offset:8192
  ds_read_b64_tr_b16 v[134:135], v97 offset:9216
  ds_read_b64_tr_b16 v[136:137], v98 offset:8192
  ds_read_b64_tr_b16 v[138:139], v98 offset:9216
  ds_read_b128 v[140:143], v96 offset:8192
  ds_read_b128 v[144:147], v96 offset:10240
  s_waitcnt lgkmcnt(12)
  v_mfma_f32_32x32x16_bf16 v[0:15], v[64:67], v[72:75], 0
  ds_read_b64_tr_b16 v[148:149], v97 offset:12288
  ds_read_b64_tr_b16 v[150:151], v97 offset:13312
  v_mfma_f32_32x32x16_bf16 v[16:31], v[64:67], v[76:79], 0
  ds_read_b64_tr_b16 v[152:153], v98 offset:12288
  ds_read_b64_tr_b16 v[154:155], v98 offset:13312
  v_mfma_f32_32x32x16_bf16 v[32:47], v[68:71], v[72:75], 0
  ds_read_b128 v[156:159], v96 offset:9216
  v_mfma_f32_32x32x16_bf16 v[48:63], v[68:71], v[76:79], 0
  ds_read_b128 v[160:163], v96 offset:11264
  s_waitcnt lgkmcnt(12)
  s_barrier
  v_mfma_f32_32x32x16_bf16 v[0:15], v[80:83], v[88:91], v[0:15]
  ds_read_b64_tr_b16 v[64:65], v97 offset:16384
  ds_read_b64_tr_b16 v[66:67], v97 offset:17408
  v_mfma_f32_32x32x16_bf16 v[16:31], v[80:83], v[92:95], v[16:31]
  ds_read_b64_tr_b16 v[68:69], v98 offset:16384
  ds_read_b64_tr_b16 v[70:71], v98 offset:17408
  v_mfma_f32_32x32x16_bf16 v[32:47], v[84:87], v[88:91], v[32:47]
  ds_read_b128 v[72:75], v96 offset:16384
  v_mfma_f32_32x32x16_bf16 v[48:63], v[84:87], v[92:95], v[48:63]
  ds_read_b128 v[76:79], v96 offset:18432
  s_waitcnt lgkmcnt(12)
  v_mfma_f32_32x32x16_bf16 v[0:15], v[132:135], v[140:143], v[0:15]
  ds_read_b64_tr_b16 v[80:81], v97 offset:20480
  ds_read_b64_tr_b16 v[82:83], v97 offset:21504
  v_mfma_f32_32x32x16_bf16 v[16:31], v[132:135], v[144:147], v[16:31]
  ds_read_b64_tr_b16 v[84:85], v98 offset:20480
  ds_read_b64_tr_b16 v[86:87], v98 offset:21504
  v_mfma_f32_32x32x16_bf16 v[32:47], v[136:139], v[140:143], v[32:47]
  ds_read_b128 v[88:91], v96 offset:17408
  v_mfma_f32_32x32x16_bf16 v[48:63], v[136:139], v[144:147], v[48:63]
  ds_read_b128 v[92:95], v96 offset:19456
  s_waitcnt lgkmcnt(12)
  v_mfma_f32_32x32x16_bf16 v[0:15], v[148:151], v[156:159], v[0:15]
  ds_read_b64_tr_b16 v[132:133], v97 offset:24576
  ds_read_b64_tr_b16 v[134:135], v97 offset:25600
  v_mfma_f32_32x32x16_bf16 v[16:31], v[148:151], v[160:163], v[16:31]
  ds_read_b64_tr_b16 v[136:137], v98 offset:24576
  ds_read_b64_tr_b16 v[138:139], v98 offset:25600
  v_mfma_f32_32x32x16_bf16 v[32:47], v[152:155], v[156:159], v[32:47]
  ds_read_b128 v[140:143], v96 offset:24576
  v_mfma_f32_32x32x16_bf16 v[48:63], v[152:155], v[160:163], v[48:63]
  ds_read_b128 v[144:147], v96 offset:26624
  s_waitcnt lgkmcnt(12)
  v_mfma_f32_32x32x16_bf16 v[0:15], v[64:67], v[72:75], v[0:15]
  ds_read_b64_tr_b16 v[148:149], v97 offset:28672
  ds_read_b64_tr_b16 v[150:151], v97 offset:29696
  v_mfma_f32_32x32x16_bf16 v[16:31], v[64:67], v[76:79], v[16:31]
  ds_read_b64_tr_b16 v[152:153], v98 offset:28672
  ds_read_b64_tr_b16 v[154:155], v98 offset:29696
  v_mfma_f32_32x32x16_bf16 v[32:47], v[68:71], v[72:75], v[32:47]
  ds_read_b128 v[156:159], v96 offset:25600
  v_mfma_f32_32x32x16_bf16 v[48:63], v[68:71], v[76:79], v[48:63]
  ds_read_b128 v[160:163], v96 offset:27648
  s_waitcnt lgkmcnt(12)
  s_barrier
  v_mfma_f32_32x32x16_bf16 v[0:15], v[80:83], v[88:91], v[0:15]
  ds_read_b64_tr_b16 v[64:65], v97 offset:32768
  ds_read_b64_tr_b16 v[66:67], v97 offset:33792
  v_mfma_f32_32x32x16_bf16 v[16:31], v[80:83], v[92:95], v[16:31]
  ds_read_b64_tr_b16 v[68:69], v98 offset:32768
  ds_read_b64_tr_b16 v[70:71], v98 offset:33792
  v_mfma_f32_32x32x16_bf16 v[32:47], v[84:87], v[88:91], v[32:47]
  ds_read_b128 v[72:75], v96 offset:32768
  v_mfma_f32_32x32x16_bf16 v[48:63], v[84:87], v[92:95], v[48:63]
  ds_read_b128 v[76:79], v96 offset:34816
  s_waitcnt lgkmcnt(12)
  v_mfma_f32_32x32x16_bf16 v[0:15], v[132:135], v[140:143], v[0:15]
  ds_read_b64_tr_b16 v[80:81], v97 offset:36864
  ds_read_b64_tr_b16 v[82:83], v97 offset:37888
  v_mfma_f32_32x32x16_bf16 v[16:31], v[132:135], v[144:147], v[16:31]
  ds_read_b64_tr_b16 v[84:85], v98 offset:36864
  ds_read_b64_tr_b16 v[86:87], v98 offset:37888
  v_mfma_f32_32x32x16_bf16 v[32:47], v[136:139], v[140:143], v[32:47]
  ds_read_b128 v[88:91], v96 offset:33792
  v_mfma_f32_32x32x16_bf16 v[48:63], v[136:139], v[144:147], v[48:63]
  ds_read_b128 v[92:95], v96 offset:35840
  s_waitcnt lgkmcnt(12)
  v_mfma_f32_32x32x16_bf16 v[0:15], v[148:151], v[156:159], v[0:15]
  ds_read_b64_tr_b16 v[132:133], v110 offset:0
  ds_read_b64_tr_b16 v[134:135], v110 offset:1024
  v_mfma_f32_32x32x16_bf16 v[16:31], v[148:151], v[160:163], v[16:31]
  ds_read_b64_tr_b16 v[136:137], v111 offset:0
  ds_read_b64_tr_b16 v[138:139], v111 offset:1024
  v_mfma_f32_32x32x16_bf16 v[32:47], v[152:155], v[156:159], v[32:47]
  ds_read_b128 v[140:143], v128 offset:0
  v_mfma_f32_32x32x16_bf16 v[48:63], v[152:155], v[160:163], v[48:63]
  ds_read_b128 v[144:147], v128 offset:2048
  s_waitcnt lgkmcnt(12)
  v_mfma_f32_32x32x16_bf16 v[0:15], v[64:67], v[72:75], v[0:15]
  ds_read_b64_tr_b16 v[148:149], v110 offset:4096
  ds_read_b64_tr_b16 v[150:151], v110 offset:5120
  v_mfma_f32_32x32x16_bf16 v[16:31], v[64:67], v[76:79], v[16:31]
  ds_read_b64_tr_b16 v[152:153], v111 offset:4096
  ds_read_b64_tr_b16 v[154:155], v111 offset:5120
  v_mfma_f32_32x32x16_bf16 v[32:47], v[68:71], v[72:75], v[32:47]
  ds_read_b128 v[156:159], v128 offset:1024
  v_mfma_f32_32x32x16_bf16 v[48:63], v[68:71], v[76:79], v[48:63]
  ds_read_b128 v[160:163], v128 offset:3072
  s_waitcnt lgkmcnt(12)
  s_barrier
  v_mfma_f32_32x32x16_bf16 v[0:15], v[80:83], v[88:91], v[0:15]
  ds_read_b64_tr_b16 v[64:65], v110 offset:8192
  ds_read_b64_tr_b16 v[66:67], v110 offset:9216
  v_mfma_f32_32x32x16_bf16 v[16:31], v[80:83], v[92:95], v[16:31]
  ds_read_b64_tr_b16 v[68:69], v111 offset:8192
  ds_read_b64_tr_b16 v[70:71], v111 offset:9216
  v_mfma_f32_32x32x16_bf16 v[32:47], v[84:87], v[88:91], v[32:47]
  ds_read_b128 v[72:75], v128 offset:8192
  v_mfma_f32_32x32x16_bf16 v[48:63], v[84:87], v[92:95], v[48:63]
  ds_read_b128 v[76:79], v128 offset:10240
  s_waitcnt lgkmcnt(12)
  v_mfma_f32_32x32x16_bf16 v[0:15], v[132:135], v[140:143], v[0:15]
  ds_read_b64_tr_b16 v[80:81], v110 offset:12288
  ds_read_b64_tr_b16 v[82:83], v110 offset:13312
  v_mfma_f32_32x32x16_bf16 v[16:31], v[132:135], v[144:147], v[16:31]
  ds_read_b64_tr_b16 v[84:85], v111 offset:12288
  ds_read_b64_tr_b16 v[86:87], v111 offset:13312
  v_mfma_f32_32x32x16_bf16 v[32:47], v[136:139], v[140:143], v[32:47]
  ds_read_b128 v[88:91], v128 offset:9216
  v_mfma_f32_32x32x16_bf16 v[48:63], v[136:139], v[144:147], v[48:63]
  ds_read_b128 v[92:95], v128 offset:11264
  s_waitcnt lgkmcnt(12)
  v_mfma_f32_32x32x16_bf16 v[0:15], v[148:151], v[156:159], v[0:15]
  ds_read_b64_tr_b16 v[132:133], v110 offset:16384
  ds_read_b64_tr_b16 v[134:135], v110 offset:17408
  v_mfma_f32_32x32x16_bf16 v[16:31], v[148:151], v[160:163], v[16:31]
  ds_read_b64_tr_b16 v[136:137], v111 offset:16384
  ds_read_b64_tr_b16 v[138:139], v111 offset:17408
  v_mfma_f32_32x32x16_bf16 v[32:47], v[152:155], v[156:159], v[32:47]
  ds_read_b128 v[140:143], v128 offset:16384
  v_mfma_f32_32x32x16_bf16 v[48:63], v[152:155], v[160:163], v[48:63]
  ds_read_b128 v[144:147], v128 offset:18432
  s_waitcnt lgkmcnt(12)
  v_mfma_f32_32x32x16_bf16 v[0:15], v[64:67], v[72:75], v[0:15]
  ds_read_b64_tr_b16 v[148:149], v110 offset:20480
  ds_read_b64_tr_b16 v[150:151], v110 offset:21504
  v_mfma_f32_32x32x16_bf16 v[16:31], v[64:67], v[76:79], v[16:31]
  ds_read_b64_tr_b16 v[152:153], v111 offset:20480
  ds_read_b64_tr_b16 v[154:155], v111 offset:21504
  v_mfma_f32_32x32x16_bf16 v[32:47], v[68:71], v[72:75], v[32:47]
  ds_read_b128 v[156:159], v128 offset:17408
  v_mfma_f32_32x32x16_bf16 v[48:63], v[68:71], v[76:79], v[48:63]
  ds_read_b128 v[160:163], v128 offset:19456
  s_waitcnt lgkmcnt(12)
  s_barrier
  v_mfma_f32_32x32x16_bf16 v[0:15], v[80:83], v[88:91], v[0:15]
  ds_read_b64_tr_b16 v[64:65], v110 offset:24576
  ds_read_b64_tr_b16 v[66:67], v110 offset:25600
  v_mfma_f32_32x32x16_bf16 v[16:31], v[80:83], v[92:95], v[16:31]
  ds_read_b64_tr_b16 v[68:69], v111 offset:24576
  ds_read_b64_tr_b16 v[70:71], v111 offset:25600
  v_mfma_f32_32x32x16_bf16 v[32:47], v[84:87], v[88:91], v[32:47]
  ds_read_b128 v[72:75], v128 offset:24576
  v_mfma_f32_32x32x16_bf16 v[48:63], v[84:87], v[92:95], v[48:63]
  ds_read_b128 v[76:79], v128 offset:26624
  s_waitcnt lgkmcnt(12)
  v_mfma_f32_32x32x16_bf16 v[0:15], v[132:135], v[140:143], v[0:15]
  ds_read_b64_tr_b16 v[80:81], v110 offset:28672
  ds_read_b64_tr_b16 v[82:83], v110 offset:29696
  v_mfma_f32_32x32x16_bf16 v[16:31], v[132:135], v[144:147], v[16:31]
  ds_read_b64_tr_b16 v[84:85], v111 offset:28672
  ds_read_b64_tr_b16 v[86:87], v111 offset:29696
  v_mfma_f32_32x32x16_bf16 v[32:47], v[136:139], v[140:143], v[32:47]
  ds_read_b128 v[88:91], v128 offset:25600
  v_mfma_f32_32x32x16_bf16 v[48:63], v[136:139], v[144:147], v[48:63]
  ds_read_b128 v[92:95], v128 offset:27648
  s_waitcnt lgkmcnt(12)
  v_mfma_f32_32x32x16_bf16 v[0:15], v[148:151], v[156:159], v[0:15]
  ds_read_b64_tr_b16 v[132:133], v110 offset:32768
  ds_read_b64_tr_b16 v[134:135], v110 offset:33792
  v_mfma_f32_32x32x16_bf16 v[16:31], v[148:151], v[160:163], v[16:31]
  ds_read_b64_tr_b16 v[136:137], v111 offset:32768
  ds_read_b64_tr_b16 v[138:139], v111 offset:33792
  v_mfma_f32_32x32x16_bf16 v[32:47], v[152:155], v[156:159], v[32:47]
  ds_read_b128 v[140:143], v128 offset:32768
  v_mfma_f32_32x32x16_bf16 v[48:63], v[152:155], v[160:163], v[48:63]
  ds_read_b128 v[144:147], v128 offset:34816
  s_waitcnt lgkmcnt(12)
  v_mfma_f32_32x32x16_bf16 v[0:15], v[64:67], v[72:75], v[0:15]
  ds_read_b64_tr_b16 v[148:149], v110 offset:36864
  ds_read_b64_tr_b16 v[150:151], v110 offset:37888
  v_mfma_f32_32x32x16_bf16 v[16:31], v[64:67], v[76:79], v[16:31]
  ds_read_b64_tr_b16 v[152:153], v111 offset:36864
  ds_read_b64_tr_b16 v[154:155], v111 offset:37888
  v_mfma_f32_32x32x16_bf16 v[32:47], v[68:71], v[72:75], v[32:47]
  ds_read_b128 v[156:159], v128 offset:33792
  v_mfma_f32_32x32x16_bf16 v[48:63], v[68:71], v[76:79], v[48:63]
  ds_read_b128 v[160:163], v128 offset:35840
  s_waitcnt lgkmcnt(12)
  s_barrier
  v_mfma_f32_32x32x16_bf16 v[0:15], v[80:83], v[88:91], v[0:15]
  ds_read_b64_tr_b16 v[64:65], v97 offset:0
  ds_read_b64_tr_b16 v[66:67], v97 offset:1024
  v_mfma_f32_32x32x16_bf16 v[16:31], v[80:83], v[92:95], v[16:31]
  ds_read_b64_tr_b16 v[68:69], v98 offset:0
  ds_read_b64_tr_b16 v[70:71], v98 offset:1024
  v_mfma_f32_32x32x16_bf16 v[32:47], v[84:87], v[88:91], v[32:47]
  ds_read_b128 v[72:75], v96 offset:0
  v_mfma_f32_32x32x16_bf16 v[48:63], v[84:87], v[92:95], v[48:63]
  ds_read_b128 v[76:79], v96 offset:2048
  s_waitcnt lgkmcnt(12)
  v_mfma_f32_32x32x16_bf16 v[0:15], v[132:135], v[140:143], v[0:15]
  ds_read_b64_tr_b16 v[80:81], v97 offset:4096
  ds_read_b64_tr_b16 v[82:83], v97 offset:5120
  v_mfma_f32_32x32x16_bf16 v[16:31], v[132:135], v[144:147], v[16:31]
  ds_read_b64_tr_b16 v[84:85], v98 offset:4096
  ds_read_b64_tr_b16 v[86:87], v98 offset:5120
  v_mfma_f32_32x32x16_bf16 v[32:47], v[136:139], v[140:143], v[32:47]
  ds_read_b128 v[88:91], v96 offset:1024
  v_mfma_f32_32x32x16_bf16 v[48:63], v[136:139], v[144:147], v[48:63]
  ds_read_b128 v[92:95], v96 offset:3072
  s_waitcnt lgkmcnt(12)
  v_mfma_f32_32x32x16_bf16 v[0:15], v[148:151], v[156:159], v[0:15]
  ds_read_b64_tr_b16 v[132:133], v97 offset:8192
  ds_read_b64_tr_b16 v[134:135], v97 offset:9216
  v_mfma_f32_32x32x16_bf16 v[16:31], v[148:151], v[160:163], v[16:31]
  ds_read_b64_tr_b16 v[136:137], v98 offset:8192
  ds_read_b64_tr_b16 v[138:139], v98 offset:9216
  v_mfma_f32_32x32x16_bf16 v[32:47], v[152:155], v[156:159], v[32:47]
  ds_read_b128 v[140:143], v96 offset:8192
  v_mfma_f32_32x32x16_bf16 v[48:63], v[152:155], v[160:163], v[48:63]
  ds_read_b128 v[144:147], v96 offset:10240
  s_waitcnt lgkmcnt(12)
  v_mfma_f32_32x32x16_bf16 v[0:15], v[64:67], v[72:75], v[0:15]
  ds_read_b64_tr_b16 v[148:149], v97 offset:12288
  ds_read_b64_tr_b16 v[150:151], v97 offset:13312
  v_mfma_f32_32x32x16_bf16 v[16:31], v[64:67], v[76:79], v[16:31]
  ds_read_b64_tr_b16 v[152:153], v98 offset:12288
  ds_read_b64_tr_b16 v[154:155], v98 offset:13312
  v_mfma_f32_32x32x16_bf16 v[32:47], v[68:71], v[72:75], v[32:47]
  ds_read_b128 v[156:159], v96 offset:9216
  v_mfma_f32_32x32x16_bf16 v[48:63], v[68:71], v[76:79], v[48:63]
  ds_read_b128 v[160:163], v96 offset:11264
  s_waitcnt lgkmcnt(12)
  s_barrier
  v_mfma_f32_32x32x16_bf16 v[0:15], v[80:83], v[88:91], v[0:15]
  ds_read_b64_tr_b16 v[64:65], v97 offset:16384
  ds_read_b64_tr_b16 v[66:67], v97 offset:17408
  v_mfma_f32_32x32x16_bf16 v[16:31], v[80:83], v[92:95], v[16:31]
  ds_read_b64_tr_b16 v[68:69], v98 offset:16384
  ds_read_b64_tr_b16 v[70:71], v98 offset:17408
  v_mfma_f32_32x32x16_bf16 v[32:47], v[84:87], v[88:91], v[32:47]
  ds_read_b128 v[72:75], v96 offset:16384
  v_mfma_f32_32x32x16_bf16 v[48:63], v[84:87], v[92:95], v[48:63]
  ds_read_b128 v[76:79], v96 offset:18432
  s_waitcnt lgkmcnt(12)
  v_mfma_f32_32x32x16_bf16 v[0:15], v[132:135], v[140:143], v[0:15]
  ds_read_b64_tr_b16 v[80:81], v97 offset:20480
  ds_read_b64_tr_b16 v[82:83], v97 offset:21504
  v_mfma_f32_32x32x16_bf16 v[16:31], v[132:135], v[144:147], v[16:31]
  ds_read_b64_tr_b16 v[84:85], v98 offset:20480
  ds_read_b64_tr_b16 v[86:87], v98 offset:21504
  v_mfma_f32_32x32x16_bf16 v[32:47], v[136:139], v[140:143], v[32:47]
  ds_read_b128 v[88:91], v96 offset:17408
  v_mfma_f32_32x32x16_bf16 v[48:63], v[136:139], v[144:147], v[48:63]
  ds_read_b128 v[92:95], v96 offset:19456
  s_waitcnt lgkmcnt(12)
  v_mfma_f32_32x32x16_bf16 v[0:15], v[148:151], v[156:159], v[0:15]
  ds_read_b64_tr_b16 v[132:133], v97 offset:24576
  ds_read_b64_tr_b16 v[134:135], v97 offset:25600
  v_mfma_f32_32x32x16_bf16 v[16:31], v[148:151], v[160:163], v[16:31]
  ds_read_b64_tr_b16 v[136:137], v98 offset:24576
  ds_read_b64_tr_b16 v[138:139], v98 offset:25600
  v_mfma_f32_32x32x16_bf16 v[32:47], v[152:155], v[156:159], v[32:47]
  ds_read_b128 v[140:143], v96 offset:24576
  v_mfma_f32_32x32x16_bf16 v[48:63], v[152:155], v[160:163], v[48:63]
  ds_read_b128 v[144:147], v96 offset:26624
  s_waitcnt lgkmcnt(12)
  v_mfma_f32_32x32x16_bf16 v[0:15], v[64:67], v[72:75], v[0:15]
  ds_read_b64_tr_b16 v[148:149], v97 offset:28672
  ds_read_b64_tr_b16 v[150:151], v97 offset:29696
  v_mfma_f32_32x32x16_bf16 v[16:31], v[64:67], v[76:79], v[16:31]
  ds_read_b64_tr_b16 v[152:153], v98 offset:28672
  ds_read_b64_tr_b16 v[154:155], v98 offset:29696
  v_mfma_f32_32x32x16_bf16 v[32:47], v[68:71], v[72:75], v[32:47]
  ds_read_b128 v[156:159], v96 offset:25600
  v_mfma_f32_32x32x16_bf16 v[48:63], v[68:71], v[76:79], v[48:63]
  ds_read_b128 v[160:163], v96 offset:27648
  s_waitcnt lgkmcnt(12)
  s_barrier
  v_mfma_f32_32x32x16_bf16 v[0:15], v[80:83], v[88:91], v[0:15]
  ds_read_b64_tr_b16 v[64:65], v97 offset:32768
  ds_read_b64_tr_b16 v[66:67], v97 offset:33792
  v_mfma_f32_32x32x16_bf16 v[16:31], v[80:83], v[92:95], v[16:31]
  ds_read_b64_tr_b16 v[68:69], v98 offset:32768
  ds_read_b64_tr_b16 v[70:71], v98 offset:33792
  v_mfma_f32_32x32x16_bf16 v[32:47], v[84:87], v[88:91], v[32:47]
  ds_read_b128 v[72:75], v96 offset:32768
  v_mfma_f32_32x32x16_bf16 v[48:63], v[84:87], v[92:95], v[48:63]
  ds_read_b128 v[76:79], v96 offset:34816
  s_waitcnt lgkmcnt(12)
  v_mfma_f32_32x32x16_bf16 v[0:15], v[132:135], v[140:143], v[0:15]
  ds_read_b64_tr_b16 v[80:81], v97 offset:36864
  ds_read_b64_tr_b16 v[82:83], v97 offset:37888
  v_mfma_f32_32x32x16_bf16 v[16:31], v[132:135], v[144:147], v[16:31]
  ds_read_b64_tr_b16 v[84:85], v98 offset:36864
  ds_read_b64_tr_b16 v[86:87], v98 offset:37888
  v_mfma_f32_32x32x16_bf16 v[32:47], v[136:139], v[140:143], v[32:47]
  ds_read_b128 v[88:91], v96 offset:33792
  v_mfma_f32_32x32x16_bf16 v[48:63], v[136:139], v[144:147], v[48:63]
  ds_read_b128 v[92:95], v96 offset:35840
  s_waitcnt lgkmcnt(12)
  v_mfma_f32_32x32x16_bf16 v[0:15], v[148:151], v[156:159], v[0:15]
  ds_read_b64_tr_b16 v[132:133], v110 offset:0
  ds_read_b64_tr_b16 v[134:135], v110 offset:1024
  v_mfma_f32_32x32x16_bf16 v[16:31], v[148:151], v[160:163], v[16:31]
  ds_read_b64_tr_b16 v[136:137], v111 offset:0
  ds_read_b64_tr_b16 v[138:139], v111 offset:1024
  v_mfma_f32_32x32x16_bf16 v[32:47], v[152:155], v[156:159], v[32:47]
  ds_read_b128 v[140:143], v128 offset:0
  v_mfma_f32_32x32x16_bf16 v[48:63], v[152:155], v[160:163], v[48:63]
  ds_read_b128 v[144:147], v128 offset:2048
  s_waitcnt lgkmcnt(12)
  v_mfma_f32_32x32x16_bf16 v[0:15], v[64:67], v[72:75], v[0:15]
  ds_read_b64_tr_b16 v[148:149], v110 offset:4096
  ds_read_b64_tr_b16 v[150:151], v110 offset:5120
  v_mfma_f32_32x32x16_bf16 v[16:31], v[64:67], v[76:79], v[16:31]
  ds_read_b64_tr_b16 v[152:153], v111 offset:4096
  ds_read_b64_tr_b16 v[154:155], v111 offset:5120
  v_mfma_f32_32x32x16_bf16 v[32:47], v[68:71], v[72:75], v[32:47]
  ds_read_b128 v[156:159], v128 offset:1024
  v_mfma_f32_32x32x16_bf16 v[48:63], v[68:71], v[76:79], v[48:63]
  ds_read_b128 v[160:163], v128 offset:3072
  s_waitcnt lgkmcnt(12)
  s_barrier
  v_mfma_f32_32x32x16_bf16 v[0:15], v[80:83], v[88:91], v[0:15]
  ds_read_b64_tr_b16 v[64:65], v110 offset:8192
  ds_read_b64_tr_b16 v[66:67], v110 offset:9216
  v_mfma_f32_32x32x16_bf16 v[16:31], v[80:83], v[92:95], v[16:31]
  ds_read_b64_tr_b16 v[68:69], v111 offset:8192
  ds_read_b64_tr_b16 v[70:71], v111 offset:9216
  v_mfma_f32_32x32x16_bf16 v[32:47], v[84:87], v[88:91], v[32:47]
  ds_read_b128 v[72:75], v128 offset:8192
  v_mfma_f32_32x32x16_bf16 v[48:63], v[84:87], v[92:95], v[48:63]
  ds_read_b128 v[76:79], v128 offset:10240
  s_waitcnt lgkmcnt(12)
  v_mfma_f32_32x32x16_bf16 v[0:15], v[132:135], v[140:143], v[0:15]
  ds_read_b64_tr_b16 v[80:81], v110 offset:12288
  ds_read_b64_tr_b16 v[82:83], v110 offset:13312
  v_mfma_f32_32x32x16_bf16 v[16:31], v[132:135], v[144:147], v[16:31]
  ds_read_b64_tr_b16 v[84:85], v111 offset:12288
  ds_read_b64_tr_b16 v[86:87], v111 offset:13312
  v_mfma_f32_32x32x16_bf16 v[32:47], v[136:139], v[140:143], v[32:47]
  ds_read_b128 v[88:91], v128 offset:9216
  v_mfma_f32_32x32x16_bf16 v[48:63], v[136:139], v[144:147], v[48:63]
  ds_read_b128 v[92:95], v128 offset:11264
  s_waitcnt lgkmcnt(12)
  v_mfma_f32_32x32x16_bf16 v[0:15], v[148:151], v[156:159], v[0:15]
  ds_read_b64_tr_b16 v[132:133], v110 offset:16384
  ds_read_b64_tr_b16 v[134:135], v110 offset:17408
  v_mfma_f32_32x32x16_bf16 v[16:31], v[148:151], v[160:163], v[16:31]
  ds_read_b64_tr_b16 v[136:137], v111 offset:16384
  ds_read_b64_tr_b16 v[138:139], v111 offset:17408
  v_mfma_f32_32x32x16_bf16 v[32:47], v[152:155], v[156:159], v[32:47]
  ds_read_b128 v[140:143], v128 offset:16384
  v_mfma_f32_32x32x16_bf16 v[48:63], v[152:155], v[160:163], v[48:63]
  ds_read_b128 v[144:147], v128 offset:18432
  s_waitcnt lgkmcnt(12)
  v_mfma_f32_32x32x16_bf16 v[0:15], v[64:67], v[72:75], v[0:15]
  ds_read_b64_tr_b16 v[148:149], v110 offset:20480
  ds_read_b64_tr_b16 v[150:151], v110 offset:21504
  v_mfma_f32_32x32x16_bf16 v[16:31], v[64:67], v[76:79], v[16:31]
  ds_read_b64_tr_b16 v[152:153], v111 offset:20480
  ds_read_b64_tr_b16 v[154:155], v111 offset:21504
  v_mfma_f32_32x32x16_bf16 v[32:47], v[68:71], v[72:75], v[32:47]
  ds_read_b128 v[156:159], v128 offset:17408
  v_mfma_f32_32x32x16_bf16 v[48:63], v[68:71], v[76:79], v[48:63]
  ds_read_b128 v[160:163], v128 offset:19456
  s_waitcnt lgkmcnt(12)
  s_barrier
  v_mfma_f32_32x32x16_bf16 v[0:15], v[80:83], v[88:91], v[0:15]
  ds_read_b64_tr_b16 v[64:65], v110 offset:24576
  ds_read_b64_tr_b16 v[66:67], v110 offset:25600
  v_mfma_f32_32x32x16_bf16 v[16:31], v[80:83], v[92:95], v[16:31]
  ds_read_b64_tr_b16 v[68:69], v111 offset:24576
  ds_read_b64_tr_b16 v[70:71], v111 offset:25600
  v_mfma_f32_32x32x16_bf16 v[32:47], v[84:87], v[88:91], v[32:47]
  ds_read_b128 v[72:75], v128 offset:24576
  v_mfma_f32_32x32x16_bf16 v[48:63], v[84:87], v[92:95], v[48:63]
  ds_read_b128 v[76:79], v128 offset:26624
  s_waitcnt lgkmcnt(12)
  v_mfma_f32_32x32x16_bf16 v[0:15], v[132:135], v[140:143], v[0:15]
  ds_read_b64_tr_b16 v[80:81], v110 offset:28672
  ds_read_b64_tr_b16 v[82:83], v110 offset:29696
  v_mfma_f32_32x32x16_bf16 v[16:31], v[132:135], v[144:147], v[16:31]
  ds_read_b64_tr_b16 v[84:85], v111 offset:28672
  ds_read_b64_tr_b16 v[86:87], v111 offset:29696
  v_mfma_f32_32x32x16_bf16 v[32:47], v[136:139], v[140:143], v[32:47]
  ds_read_b128 v[88:91], v128 offset:25600
  v_mfma_f32_32x32x16_bf16 v[48:63], v[136:139], v[144:147], v[48:63]
  ds_read_b128 v[92:95], v128 offset:27648
  s_waitcnt lgkmcnt(12)
  v_mfma_f32_32x32x16_bf16 v[0:15], v[148:151], v[156:159], v[0:15]
  ds_read_b64_tr_b16 v[132:133], v110 offset:32768
  ds_read_b64_tr_b16 v[134:135], v110 offset:33792
  v_mfma_f32_32x32x16_bf16 v[16:31], v[148:151], v[160:163], v[16:31]
  ds_read_b64_tr_b16 v[136:137], v111 offset:32768
  ds_read_b64_tr_b16 v[138:139], v111 offset:33792
  v_mfma_f32_32x32x16_bf16 v[32:47], v[152:155], v[156:159], v[32:47]
  ds_read_b128 v[140:143], v128 offset:32768
  v_mfma_f32_32x32x16_bf16 v[48:63], v[152:155], v[160:163], v[48:63]
  ds_read_b128 v[144:147], v128 offset:34816
  s_waitcnt lgkmcnt(12)
  v_mfma_f32_32x32x16_bf16 v[0:15], v[64:67], v[72:75], v[0:15]
  ds_read_b64_tr_b16 v[148:149], v110 offset:36864
  ds_read_b64_tr_b16 v[150:151], v110 offset:37888
  v_mfma_f32_32x32x16_bf16 v[16:31], v[64:67], v[76:79], v[16:31]
  ds_read_b64_tr_b16 v[152:153], v111 offset:36864
  ds_read_b64_tr_b16 v[154:155], v111 offset:37888
  v_mfma_f32_32x32x16_bf16 v[32:47], v[68:71], v[72:75], v[32:47]
  ds_read_b128 v[156:159], v128 offset:33792
  v_mfma_f32_32x32x16_bf16 v[48:63], v[68:71], v[76:79], v[48:63]
  ds_read_b128 v[160:163], v128 offset:35840
  s_waitcnt lgkmcnt(12)
  s_barrier
  v_mfma_f32_32x32x16_bf16 v[0:15], v[80:83], v[88:91], v[0:15]
  ds_read_b64_tr_b16 v[64:65], v97 offset:0
  ds_read_b64_tr_b16 v[66:67], v97 offset:1024
  v_mfma_f32_32x32x16_bf16 v[16:31], v[80:83], v[92:95], v[16:31]
  ds_read_b64_tr_b16 v[68:69], v98 offset:0
  ds_read_b64_tr_b16 v[70:71], v98 offset:1024
  v_mfma_f32_32x32x16_bf16 v[32:47], v[84:87], v[88:91], v[32:47]
  ds_read_b128 v[72:75], v96 offset:0
  v_mfma_f32_32x32x16_bf16 v[48:63], v[84:87], v[92:95], v[48:63]
  ds_read_b128 v[76:79], v96 offset:2048
  s_waitcnt lgkmcnt(12)
  v_mfma_f32_32x32x16_bf16 v[0:15], v[132:135], v[140:143], v[0:15]
  ds_read_b64_tr_b16 v[80:81], v97 offset:4096
  ds_read_b64_tr_b16 v[82:83], v97 offset:5120
  v_mfma_f32_32x32x16_bf16 v[16:31], v[132:135], v[144:147], v[16:31]
  ds_read_b64_tr_b16 v[84:85], v98 offset:4096
  ds_read_b64_tr_b16 v[86:87], v98 offset:5120
  v_mfma_f32_32x32x16_bf16 v[32:47], v[136:139], v[140:143], v[32:47]
  ds_read_b128 v[88:91], v96 offset:1024
  v_mfma_f32_32x32x16_bf16 v[48:63], v[136:139], v[144:147], v[48:63]
  ds_read_b128 v[92:95], v96 offset:3072
  s_waitcnt lgkmcnt(12)
  v_mfma_f32_32x32x16_bf16 v[0:15], v[148:151], v[156:159], v[0:15]
  ds_read_b64_tr_b16 v[132:133], v97 offset:8192
  ds_read_b64_tr_b16 v[134:135], v97 offset:9216
  v_mfma_f32_32x32x16_bf16 v[16:31], v[148:151], v[160:163], v[16:31]
  ds_read_b64_tr_b16 v[136:137], v98 offset:8192
  ds_read_b64_tr_b16 v[138:139], v98 offset:9216
  v_mfma_f32_32x32x16_bf16 v[32:47], v[152:155], v[156:159], v[32:47]
  ds_read_b128 v[140:143], v96 offset:8192
  v_mfma_f32_32x32x16_bf16 v[48:63], v[152:155], v[160:163], v[48:63]
  ds_read_b128 v[144:147], v96 offset:10240
  s_waitcnt lgkmcnt(12)
  v_mfma_f32_32x32x16_bf16 v[0:15], v[64:67], v[72:75], v[0:15]
  ds_read_b64_tr_b16 v[148:149], v97 offset:12288
  ds_read_b64_tr_b16 v[150:151], v97 offset:13312
  v_mfma_f32_32x32x16_bf16 v[16:31], v[64:67], v[76:79], v[16:31]
  ds_read_b64_tr_b16 v[152:153], v98 offset:12288
  ds_read_b64_tr_b16 v[154:155], v98 offset:13312
  v_mfma_f32_32x32x16_bf16 v[32:47], v[68:71], v[72:75], v[32:47]
  ds_read_b128 v[156:159], v96 offset:9216
  v_mfma_f32_32x32x16_bf16 v[48:63], v[68:71], v[76:79], v[48:63]
  ds_read_b128 v[160:163], v96 offset:11264
  s_waitcnt lgkmcnt(12)
  s_barrier
  v_mfma_f32_32x32x16_bf16 v[0:15], v[80:83], v[88:91], v[0:15]
  ds_read_b64_tr_b16 v[64:65], v97 offset:16384
  ds_read_b64_tr_b16 v[66:67], v97 offset:17408
  v_mfma_f32_32x32x16_bf16 v[16:31], v[80:83], v[92:95], v[16:31]
  ds_read_b64_tr_b16 v[68:69], v98 offset:16384
  ds_read_b64_tr_b16 v[70:71], v98 offset:17408
  v_mfma_f32_32x32x16_bf16 v[32:47], v[84:87], v[88:91], v[32:47]
  ds_read_b128 v[72:75], v96 offset:16384
  v_mfma_f32_32x32x16_bf16 v[48:63], v[84:87], v[92:95], v[48:63]
  ds_read_b128 v[76:79], v96 offset:18432
  s_waitcnt lgkmcnt(12)
  v_mfma_f32_32x32x16_bf16 v[0:15], v[132:135], v[140:143], v[0:15]
  ds_read_b64_tr_b16 v[80:81], v97 offset:20480
  ds_read_b64_tr_b16 v[82:83], v97 offset:21504
  v_mfma_f32_32x32x16_bf16 v[16:31], v[132:135], v[144:147], v[16:31]
  ds_read_b64_tr_b16 v[84:85], v98 offset:20480
  ds_read_b64_tr_b16 v[86:87], v98 offset:21504
  v_mfma_f32_32x32x16_bf16 v[32:47], v[136:139], v[140:143], v[32:47]
  ds_read_b128 v[88:91], v96 offset:17408
  v_mfma_f32_32x32x16_bf16 v[48:63], v[136:139], v[144:147], v[48:63]
  ds_read_b128 v[92:95], v96 offset:19456
  s_waitcnt lgkmcnt(12)
  v_mfma_f32_32x32x16_bf16 v[0:15], v[148:151], v[156:159], v[0:15]
  ds_read_b64_tr_b16 v[132:133], v97 offset:24576
  ds_read_b64_tr_b16 v[134:135], v97 offset:25600
  v_mfma_f32_32x32x16_bf16 v[16:31], v[148:151], v[160:163], v[16:31]
  ds_read_b64_tr_b16 v[136:137], v98 offset:24576
  ds_read_b64_tr_b16 v[138:139], v98 offset:25600
  v_mfma_f32_32x32x16_bf16 v[32:47], v[152:155], v[156:159], v[32:47]
  ds_read_b128 v[140:143], v96 offset:24576
  v_mfma_f32_32x32x16_bf16 v[48:63], v[152:155], v[160:163], v[48:63]
  ds_read_b128 v[144:147], v96 offset:26624
  s_waitcnt lgkmcnt(12)
  v_mfma_f32_32x32x16_bf16 v[0:15], v[64:67], v[72:75], v[0:15]
  ds_read_b64_tr_b16 v[148:149], v97 offset:28672
  ds_read_b64_tr_b16 v[150:151], v97 offset:29696
  v_mfma_f32_32x32x16_bf16 v[16:31], v[64:67], v[76:79], v[16:31]
  ds_read_b64_tr_b16 v[152:153], v98 offset:28672
  ds_read_b64_tr_b16 v[154:155], v98 offset:29696
  v_mfma_f32_32x32x16_bf16 v[32:47], v[68:71], v[72:75], v[32:47]
  ds_read_b128 v[156:159], v96 offset:25600
  v_mfma_f32_32x32x16_bf16 v[48:63], v[68:71], v[76:79], v[48:63]
  ds_read_b128 v[160:163], v96 offset:27648
  s_waitcnt lgkmcnt(12)
  s_barrier
  v_mfma_f32_32x32x16_bf16 v[0:15], v[80:83], v[88:91], v[0:15]
  ds_read_b64_tr_b16 v[64:65], v97 offset:32768
  ds_read_b64_tr_b16 v[66:67], v97 offset:33792
  v_mfma_f32_32x32x16_bf16 v[16:31], v[80:83], v[92:95], v[16:31]
  ds_read_b64_tr_b16 v[68:69], v98 offset:32768
  ds_read_b64_tr_b16 v[70:71], v98 offset:33792
  v_mfma_f32_32x32x16_bf16 v[32:47], v[84:87], v[88:91], v[32:47]
  ds_read_b128 v[72:75], v96 offset:32768
  v_mfma_f32_32x32x16_bf16 v[48:63], v[84:87], v[92:95], v[48:63]
  ds_read_b128 v[76:79], v96 offset:34816
  s_waitcnt lgkmcnt(12)
  v_mfma_f32_32x32x16_bf16 v[0:15], v[132:135], v[140:143], v[0:15]
  ds_read_b64_tr_b16 v[80:81], v97 offset:36864
  ds_read_b64_tr_b16 v[82:83], v97 offset:37888
  v_mfma_f32_32x32x16_bf16 v[16:31], v[132:135], v[144:147], v[16:31]
  ds_read_b64_tr_b16 v[84:85], v98 offset:36864
  ds_read_b64_tr_b16 v[86:87], v98 offset:37888
  v_mfma_f32_32x32x16_bf16 v[32:47], v[136:139], v[140:143], v[32:47]
  ds_read_b128 v[88:91], v96 offset:33792
  v_mfma_f32_32x32x16_bf16 v[48:63], v[136:139], v[144:147], v[48:63]
  ds_read_b128 v[92:95], v96 offset:35840
  s_waitcnt lgkmcnt(12)
  v_mfma_f32_32x32x16_bf16 v[0:15], v[148:151], v[156:159], v[0:15]
  ds_read_b64_tr_b16 v[132:133], v110 offset:0
  ds_read_b64_tr_b16 v[134:135], v110 offset:1024
  v_mfma_f32_32x32x16_bf16 v[16:31], v[148:151], v[160:163], v[16:31]
  ds_read_b64_tr_b16 v[136:137], v111 offset:0
  ds_read_b64_tr_b16 v[138:139], v111 offset:1024
  v_mfma_f32_32x32x16_bf16 v[32:47], v[152:155], v[156:159], v[32:47]
  ds_read_b128 v[140:143], v128 offset:0
  v_mfma_f32_32x32x16_bf16 v[48:63], v[152:155], v[160:163], v[48:63]
  ds_read_b128 v[144:147], v128 offset:2048
  s_waitcnt lgkmcnt(12)
  v_mfma_f32_32x32x16_bf16 v[0:15], v[64:67], v[72:75], v[0:15]
  ds_read_b64_tr_b16 v[148:149], v110 offset:4096
  ds_read_b64_tr_b16 v[150:151], v110 offset:5120
  v_mfma_f32_32x32x16_bf16 v[16:31], v[64:67], v[76:79], v[16:31]
  ds_read_b64_tr_b16 v[152:153], v111 offset:4096
  ds_read_b64_tr_b16 v[154:155], v111 offset:5120
  v_mfma_f32_32x32x16_bf16 v[32:47], v[68:71], v[72:75], v[32:47]
  ds_read_b128 v[156:159], v128 offset:1024
  v_mfma_f32_32x32x16_bf16 v[48:63], v[68:71], v[76:79], v[48:63]
  ds_read_b128 v[160:163], v128 offset:3072
  s_waitcnt lgkmcnt(12)
  s_barrier
  v_mfma_f32_32x32x16_bf16 v[0:15], v[80:83], v[88:91], v[0:15]
  ds_read_b64_tr_b16 v[64:65], v110 offset:8192
  ds_read_b64_tr_b16 v[66:67], v110 offset:9216
  v_mfma_f32_32x32x16_bf16 v[16:31], v[80:83], v[92:95], v[16:31]
  ds_read_b64_tr_b16 v[68:69], v111 offset:8192
  ds_read_b64_tr_b16 v[70:71], v111 offset:9216
  v_mfma_f32_32x32x16_bf16 v[32:47], v[84:87], v[88:91], v[32:47]
  ds_read_b128 v[72:75], v128 offset:8192
  v_mfma_f32_32x32x16_bf16 v[48:63], v[84:87], v[92:95], v[48:63]
  ds_read_b128 v[76:79], v128 offset:10240
  s_waitcnt lgkmcnt(12)
  v_mfma_f32_32x32x16_bf16 v[0:15], v[132:135], v[140:143], v[0:15]
  ds_read_b64_tr_b16 v[80:81], v110 offset:12288
  ds_read_b64_tr_b16 v[82:83], v110 offset:13312
  v_mfma_f32_32x32x16_bf16 v[16:31], v[132:135], v[144:147], v[16:31]
  ds_read_b64_tr_b16 v[84:85], v111 offset:12288
  ds_read_b64_tr_b16 v[86:87], v111 offset:13312
  v_mfma_f32_32x32x16_bf16 v[32:47], v[136:139], v[140:143], v[32:47]
  ds_read_b128 v[88:91], v128 offset:9216
  v_mfma_f32_32x32x16_bf16 v[48:63], v[136:139], v[144:147], v[48:63]
  ds_read_b128 v[92:95], v128 offset:11264
  s_waitcnt lgkmcnt(12)
  v_mfma_f32_32x32x16_bf16 v[0:15], v[148:151], v[156:159], v[0:15]
  ds_read_b64_tr_b16 v[132:133], v110 offset:16384
  ds_read_b64_tr_b16 v[134:135], v110 offset:17408
  v_mfma_f32_32x32x16_bf16 v[16:31], v[148:151], v[160:163], v[16:31]
  ds_read_b64_tr_b16 v[136:137], v111 offset:16384
  ds_read_b64_tr_b16 v[138:139], v111 offset:17408
  v_mfma_f32_32x32x16_bf16 v[32:47], v[152:155], v[156:159], v[32:47]
  ds_read_b128 v[140:143], v128 offset:16384
  v_mfma_f32_32x32x16_bf16 v[48:63], v[152:155], v[160:163], v[48:63]
  ds_read_b128 v[144:147], v128 offset:18432
  s_waitcnt lgkmcnt(12)
  v_mfma_f32_32x32x16_bf16 v[0:15], v[64:67], v[72:75], v[0:15]
  ds_read_b64_tr_b16 v[148:149], v110 offset:20480
  ds_read_b64_tr_b16 v[150:151], v110 offset:21504
  v_mfma_f32_32x32x16_bf16 v[16:31], v[64:67], v[76:79], v[16:31]
  ds_read_b64_tr_b16 v[152:153], v111 offset:20480
  ds_read_b64_tr_b16 v[154:155], v111 offset:21504
  v_mfma_f32_32x32x16_bf16 v[32:47], v[68:71], v[72:75], v[32:47]
  ds_read_b128 v[156:159], v128 offset:17408
  v_mfma_f32_32x32x16_bf16 v[48:63], v[68:71], v[76:79], v[48:63]
  ds_read_b128 v[160:163], v128 offset:19456
  s_waitcnt lgkmcnt(12)
  s_barrier
  v_mfma_f32_32x32x16_bf16 v[0:15], v[80:83], v[88:91], v[0:15]
  ds_read_b64_tr_b16 v[64:65], v110 offset:24576
  ds_read_b64_tr_b16 v[66:67], v110 offset:25600
  v_mfma_f32_32x32x16_bf16 v[16:31], v[80:83], v[92:95], v[16:31]
  ds_read_b64_tr_b16 v[68:69], v111 offset:24576
  ds_read_b64_tr_b16 v[70:71], v111 offset:25600
  v_mfma_f32_32x32x16_bf16 v[32:47], v[84:87], v[88:91], v[32:47]
  ds_read_b128 v[72:75], v128 offset:24576
  v_mfma_f32_32x32x16_bf16 v[48:63], v[84:87], v[92:95], v[48:63]
  ds_read_b128 v[76:79], v128 offset:26624
  s_waitcnt lgkmcnt(12)
  v_mfma_f32_32x32x16_bf16 v[0:15], v[132:135], v[140:143], v[0:15]
  ds_read_b64_tr_b16 v[80:81], v110 offset:28672
  ds_read_b64_tr_b16 v[82:83], v110 offset:29696
  v_mfma_f32_32x32x16_bf16 v[16:31], v[132:135], v[144:147], v[16:31]
  ds_read_b64_tr_b16 v[84:85], v111 offset:28672
  ds_read_b64_tr_b16 v[86:87], v111 offset:29696
  v_mfma_f32_32x32x16_bf16 v[32:47], v[136:139], v[140:143], v[32:47]
  ds_read_b128 v[88:91], v128 offset:25600
  v_mfma_f32_32x32x16_bf16 v[48:63], v[136:139], v[144:147], v[48:63]
  ds_read_b128 v[92:95], v128 offset:27648
  s_waitcnt lgkmcnt(12)
  v_mfma_f32_32x32x16_bf16 v[0:15], v[148:151], v[156:159], v[0:15]
  ds_read_b64_tr_b16 v[132:133], v110 offset:32768
  ds_read_b64_tr_b16 v[134:135], v110 offset:33792
  v_mfma_f32_32x32x16_bf16 v[16:31], v[148:151], v[160:163], v[16:31]
  ds_read_b64_tr_b16 v[136:137], v111 offset:32768
  ds_read_b64_tr_b16 v[138:139], v111 offset:33792
  v_mfma_f32_32x32x16_bf16 v[32:47], v[152:155], v[156:159], v[32:47]
  ds_read_b128 v[140:143], v128 offset:32768
  v_mfma_f32_32x32x16_bf16 v[48:63], v[152:155], v[160:163], v[48:63]
  ds_read_b128 v[144:147], v128 offset:34816
  s_waitcnt lgkmcnt(12)
  v_mfma_f32_32x32x16_bf16 v[0:15], v[64:67], v[72:75], v[0:15]
  ds_read_b64_tr_b16 v[148:149], v110 offset:36864
  ds_read_b64_tr_b16 v[150:151], v110 offset:37888
  v_mfma_f32_32x32x16_bf16 v[16:31], v[64:67], v[76:79], v[16:31]
  ds_read_b64_tr_b16 v[152:153], v111 offset:36864
  ds_read_b64_tr_b16 v[154:155], v111 offset:37888
  v_mfma_f32_32x32x16_bf16 v[32:47], v[68:71], v[72:75], v[32:47]
  ds_read_b128 v[156:159], v128 offset:33792
  v_mfma_f32_32x32x16_bf16 v[48:63], v[68:71], v[76:79], v[48:63]
  ds_read_b128 v[160:163], v128 offset:35840
  s_waitcnt lgkmcnt(12)
  s_barrier
  v_mfma_f32_32x32x16_bf16 v[0:15], v[80:83], v[88:91], v[0:15]
  ds_read_b64_tr_b16 v[64:65], v97 offset:0
  ds_read_b64_tr_b16 v[66:67], v97 offset:1024
  v_mfma_f32_32x32x16_bf16 v[16:31], v[80:83], v[92:95], v[16:31]
  ds_read_b64_tr_b16 v[68:69], v98 offset:0
  ds_read_b64_tr_b16 v[70:71], v98 offset:1024
  v_mfma_f32_32x32x16_bf16 v[32:47], v[84:87], v[88:91], v[32:47]
  ds_read_b128 v[72:75], v96 offset:0
  v_mfma_f32_32x32x16_bf16 v[48:63], v[84:87], v[92:95], v[48:63]
  ds_read_b128 v[76:79], v96 offset:2048
  s_waitcnt lgkmcnt(12)
  v_mfma_f32_32x32x16_bf16 v[0:15], v[132:135], v[140:143], v[0:15]
  ds_read_b64_tr_b16 v[80:81], v97 offset:4096
  ds_read_b64_tr_b16 v[82:83], v97 offset:5120
  v_mfma_f32_32x32x16_bf16 v[16:31], v[132:135], v[144:147], v[16:31]
  ds_read_b64_tr_b16 v[84:85], v98 offset:4096
  ds_read_b64_tr_b16 v[86:87], v98 offset:5120
  v_mfma_f32_32x32x16_bf16 v[32:47], v[136:139], v[140:143], v[32:47]
  ds_read_b128 v[88:91], v96 offset:1024
  v_mfma_f32_32x32x16_bf16 v[48:63], v[136:139], v[144:147], v[48:63]
  ds_read_b128 v[92:95], v96 offset:3072
  s_waitcnt lgkmcnt(12)
  v_mfma_f32_32x32x16_bf16 v[0:15], v[148:151], v[156:159], v[0:15]
  ds_read_b64_tr_b16 v[132:133], v97 offset:8192
  ds_read_b64_tr_b16 v[134:135], v97 offset:9216
  v_mfma_f32_32x32x16_bf16 v[16:31], v[148:151], v[160:163], v[16:31]
  ds_read_b64_tr_b16 v[136:137], v98 offset:8192
  ds_read_b64_tr_b16 v[138:139], v98 offset:9216
  v_mfma_f32_32x32x16_bf16 v[32:47], v[152:155], v[156:159], v[32:47]
  ds_read_b128 v[140:143], v96 offset:8192
  v_mfma_f32_32x32x16_bf16 v[48:63], v[152:155], v[160:163], v[48:63]
  ds_read_b128 v[144:147], v96 offset:10240
  s_waitcnt lgkmcnt(12)
  v_mfma_f32_32x32x16_bf16 v[0:15], v[64:67], v[72:75], v[0:15]
  ds_read_b64_tr_b16 v[148:149], v97 offset:12288
  ds_read_b64_tr_b16 v[150:151], v97 offset:13312
  v_mfma_f32_32x32x16_bf16 v[16:31], v[64:67], v[76:79], v[16:31]
  ds_read_b64_tr_b16 v[152:153], v98 offset:12288
  ds_read_b64_tr_b16 v[154:155], v98 offset:13312
  v_mfma_f32_32x32x16_bf16 v[32:47], v[68:71], v[72:75], v[32:47]
  ds_read_b128 v[156:159], v96 offset:9216
  v_mfma_f32_32x32x16_bf16 v[48:63], v[68:71], v[76:79], v[48:63]
  ds_read_b128 v[160:163], v96 offset:11264
  s_waitcnt lgkmcnt(12)
  v_mfma_f32_32x32x16_bf16 v[0:15], v[80:83], v[88:91], v[0:15]
  v_mfma_f32_32x32x16_bf16 v[16:31], v[80:83], v[92:95], v[16:31]
  v_mfma_f32_32x32x16_bf16 v[32:47], v[84:87], v[88:91], v[32:47]
  v_mfma_f32_32x32x16_bf16 v[48:63], v[84:87], v[92:95], v[48:63]
  s_waitcnt lgkmcnt(6)
  v_mfma_f32_32x32x16_bf16 v[0:15], v[132:135], v[140:143], v[0:15]
  v_mfma_f32_32x32x16_bf16 v[16:31], v[132:135], v[144:147], v[16:31]
  v_mfma_f32_32x32x16_bf16 v[32:47], v[136:139], v[140:143], v[32:47]
  v_mfma_f32_32x32x16_bf16 v[48:63], v[136:139], v[144:147], v[48:63]
  s_waitcnt lgkmcnt(0)
  v_mfma_f32_32x32x16_bf16 v[0:15], v[148:151], v[156:159], v[0:15]
  v_mfma_f32_32x32x16_bf16 v[16:31], v[148:151], v[160:163], v[16:31]
  v_mfma_f32_32x32x16_bf16 v[32:47], v[152:155], v[156:159], v[32:47]
  v_mfma_f32_32x32x16_bf16 v[48:63], v[152:155], v[160:163], v[48:63]
  s_mul_i32 s55, s39, 5
  s_add_u32 s55, s55, s38
  s_lshl_b32 s56, s55, 6
  s_lshl_b32 s57, s37, 2
  s_add_u32 s57, s57, s36
  s_add_u32 s57, s57, s56
  s_lshl_b32 s57, s57, 12
  s_add_u32 s57, s57, 16777216
  s_nop 7
  s_cmp_eq_u32 s37, 0
  s_cbranch_scc1 K_skipst0
  s_add_u32 s58, s57, 0
  buffer_store_dwordx4 v[0:3], v99, s[32:35], s58 offen offset:0 sc1
  buffer_store_dwordx4 v[4:7], v99, s[32:35], s58 offen offset:1024 sc1
  buffer_store_dwordx4 v[8:11], v99, s[32:35], s58 offen offset:2048 sc1
  buffer_store_dwordx4 v[12:15], v99, s[32:35], s58 offen offset:3072 sc1
K_skipst0:
  s_cmp_eq_u32 s37, 1
  s_cbranch_scc1 K_skipst1
  s_add_u32 s58, s57, 65536
  buffer_store_dwordx4 v[16:19], v99, s[32:35], s58 offen offset:0 sc1
  buffer_store_dwordx4 v[20:23], v99, s[32:35], s58 offen offset:1024 sc1
  buffer_store_dwordx4 v[24:27], v99, s[32:35], s58 offen offset:2048 sc1
  buffer_store_dwordx4 v[28:31], v99, s[32:35], s58 offen offset:3072 sc1
K_skipst1:
  s_cmp_eq_u32 s37, 2
  s_cbranch_scc1 K_skipst2
  s_add_u32 s58, s57, 131072
  buffer_store_dwordx4 v[32:35], v99, s[32:35], s58 offen offset:0 sc1
  buffer_store_dwordx4 v[36:39], v99, s[32:35], s58 offen offset:1024 sc1
  buffer_store_dwordx4 v[40:43], v99, s[32:35], s58 offen offset:2048 sc1
  buffer_store_dwordx4 v[44:47], v99, s[32:35], s58 offen offset:3072 sc1
K_skipst2:
  s_cmp_eq_u32 s37, 3
  s_cbranch_scc1 K_skipst3
  s_add_u32 s58, s57, 196608
  buffer_store_dwordx4 v[48:51], v99, s[32:35], s58 offen offset:0 sc1
  buffer_store_dwordx4 v[52:55], v99, s[32:35], s58 offen offset:1024 sc1
  buffer_store_dwordx4 v[56:59], v99, s[32:35], s58 offen offset:2048 sc1
  buffer_store_dwordx4 v[60:63], v99, s[32:35], s58 offen offset:3072 sc1
K_skipst3:
  s_cmp_eq_u32 s37, 0
  s_cbranch_scc0 K_nk0
  v_mov_b32 v112, v0
  v_mov_b32 v113, v1
  v_mov_b32 v114, v2
  v_mov_b32 v115, v3
  v_mov_b32 v116, v4
  v_mov_b32 v117, v5
  v_mov_b32 v118, v6
  v_mov_b32 v119, v7
  v_mov_b32 v120, v8
  v_mov_b32 v121, v9
  v_mov_b32 v122, v10
  v_mov_b32 v123, v11
  v_mov_b32 v124, v12
  v_mov_b32 v125, v13
  v_mov_b32 v126, v14
  v_mov_b32 v127, v15
K_nk0:
  s_cmp_eq_u32 s37, 1
  s_cbranch_scc0 K_nk1
  v_mov_b32 v112, v16
  v_mov_b32 v113, v17
  v_mov_b32 v114, v18
  v_mov_b32 v115, v19
  v_mov_b32 v116, v20
  v_mov_b32 v117, v21
  v_mov_b32 v118, v22
  v_mov_b32 v119, v23
  v_mov_b32 v120, v24
  v_mov_b32 v121, v25
  v_mov_b32 v122, v26
  v_mov_b32 v123, v27
  v_mov_b32 v124, v28
  v_mov_b32 v125, v29
  v_mov_b32 v126, v30
  v_mov_b32 v127, v31
K_nk1:
  s_cmp_eq_u32 s37, 2
  s_cbranch_scc0 K_nk2
  v_mov_b32 v112, v32
  v_mov_b32 v113, v33
  v_mov_b32 v114, v34
  v_mov_b32 v115, v35
  v_mov_b32 v116, v36
  v_mov_b32 v117, v37
  v_mov_b32 v118, v38
  v_mov_b32 v119, v39
  v_mov_b32 v120, v40
  v_mov_b32 v121, v41
  v_mov_b32 v122, v42
  v_mov_b32 v123, v43
  v_mov_b32 v124, v44
  v_mov_b32 v125, v45
  v_mov_b32 v126, v46
  v_mov_b32 v127, v47
K_nk2:
  s_cmp_eq_u32 s37, 3
  s_cbranch_scc0 K_nk3
  v_mov_b32 v112, v48
  v_mov_b32 v113, v49
  v_mov_b32 v114, v50
  v_mov_b32 v115, v51
  v_mov_b32 v116, v52
  v_mov_b32 v117, v53
  v_mov_b32 v118, v54
  v_mov_b32 v119, v55
  v_mov_b32 v120, v56
  v_mov_b32 v121, v57
  v_mov_b32 v122, v58
  v_mov_b32 v123, v59
  v_mov_b32 v124, v60
  v_mov_b32 v125, v61
  v_mov_b32 v126, v62
  v_mov_b32 v127, v63
K_nk3:
  s_waitcnt vmcnt(0)
  s_barrier
  s_add_u32 s58, s55, 32
  s_lshl_b32 s58, s58, 8
  s_add_u32 s58, s58, 50331648
  s_cmp_eq_u32 s36, 0
  s_cbranch_scc0 K_poll2_ok
  v_mov_b32 v94, 1
  s_mov_b64 exec, 1
  buffer_atomic_add v94, off, s[32:35], s58 sc1
  s_mov_b64 exec, -1
  s_mov_b32 s61, 0
K_poll2:
  buffer_load_dword v95, off, s[32:35], s58 sc1
  s_waitcnt vmcnt(0)
  v_readfirstlane_b32 s62, v95
  s_add_u32 s61, s61, 1
  s_cmp_ge_u32 s62, 4
  s_cbranch_scc1 K_poll2_ok
  s_cmp_ge_u32 s61, 20000
  s_cbranch_scc1 K_poll2_ok
  s_sleep 8
  s_branch K_poll2
K_poll2_ok:
  s_barrier
  s_lshl_b32 s57, s37, 4
  s_add_u32 s57, s57, s56
  s_add_u32 s57, s57, s36
  s_add_u32 s58, s37, 1
  s_and_b32 s58, s58, 3
  s_lshl_b32 s58, s58, 2
  s_add_u32 s58, s58, s57
  s_lshl_b32 s58, s58, 12
  s_add_u32 s58, s58, 16777216
  buffer_load_dwordx4 v[0:3], v99, s[32:35], s58 offen offset:0 sc1
  buffer_load_dwordx4 v[4:7], v99, s[32:35], s58 offen offset:1024 sc1
  buffer_load_dwordx4 v[8:11], v99, s[32:35], s58 offen offset:2048 sc1
  buffer_load_dwordx4 v[12:15], v99, s[32:35], s58 offen offset:3072 sc1
  s_add_u32 s58, s37, 2
  s_and_b32 s58, s58, 3
  s_lshl_b32 s58, s58, 2
  s_add_u32 s58, s58, s57
  s_lshl_b32 s58, s58, 12
  s_add_u32 s58, s58, 16777216
  buffer_load_dwordx4 v[16:19], v99, s[32:35], s58 offen offset:0 sc1
  buffer_load_dwordx4 v[20:23], v99, s[32:35], s58 offen offset:1024 sc1
  buffer_load_dwordx4 v[24:27], v99, s[32:35], s58 offen offset:2048 sc1
  buffer_load_dwordx4 v[28:31], v99, s[32:35], s58 offen offset:3072 sc1
  s_add_u32 s58, s37, 3
  s_and_b32 s58, s58, 3
  s_lshl_b32 s58, s58, 2
  s_add_u32 s58, s58, s57
  s_lshl_b32 s58, s58, 12
  s_add_u32 s58, s58, 16777216
  buffer_load_dwordx4 v[32:35], v99, s[32:35], s58 offen offset:0 sc1
  buffer_load_dwordx4 v[36:39], v99, s[32:35], s58 offen offset:1024 sc1
  buffer_load_dwordx4 v[40:43], v99, s[32:35], s58 offen offset:2048 sc1
  buffer_load_dwordx4 v[44:47], v99, s[32:35], s58 offen offset:3072 sc1
  s_lshl_b32 s55, s39, 2
  s_lshl_b32 s56, s48, 1
  s_add_u32 s55, s55, s56
  s_and_b32 s56, s37, 1
  s_add_u32 s55, s55, s56
  s_mul_i32 s55, s55, 40960
  s_lshl_b32 s56, s38, 2
  s_add_u32 s56, s56, s52
  s_lshr_b32 s57, s37, 1
  s_add_u32 s56, s56, s57
  s_lshl_b32 s56, s56, 6
  s_add_u32 s55, s55, s56
  s_movk_i32 s56, 1280
  v_mul_lo_u32 v94, v103, s56
  v_lshlrev_b32 v95, 4, v104
  v_add_u32 v94, v94, v95
  s_waitcnt vmcnt(0)
  v_add_f32 v0, v0, v16
  v_add_f32 v112, v112, v32
  v_add_f32 v0, v0, v112
  v_add_f32 v1, v1, v17
  v_add_f32 v113, v113, v33
  v_add_f32 v1, v1, v113
  v_add_f32 v2, v2, v18
  v_add_f32 v114, v114, v34
  v_add_f32 v2, v2, v114
  v_add_f32 v3, v3, v19
  v_add_f32 v115, v115, v35
  v_add_f32 v3, v3, v115
  v_add_f32 v4, v4, v20
  v_add_f32 v116, v116, v36
  v_add_f32 v4, v4, v116
  v_add_f32 v5, v5, v21
  v_add_f32 v117, v117, v37
  v_add_f32 v5, v5, v117
  v_add_f32 v6, v6, v22
  v_add_f32 v118, v118, v38
  v_add_f32 v6, v6, v118
  v_add_f32 v7, v7, v23
  v_add_f32 v119, v119, v39
  v_add_f32 v7, v7, v119
  v_add_f32 v8, v8, v24
  v_add_f32 v120, v120, v40
  v_add_f32 v8, v8, v120
  v_add_f32 v9, v9, v25
  v_add_f32 v121, v121, v41
  v_add_f32 v9, v9, v121
  v_add_f32 v10, v10, v26
  v_add_f32 v122, v122, v42
  v_add_f32 v10, v10, v122
  v_add_f32 v11, v11, v27
  v_add_f32 v123, v123, v43
  v_add_f32 v11, v11, v123
  v_add_f32 v12, v12, v28
  v_add_f32 v124, v124, v44
  v_add_f32 v12, v12, v124
  v_add_f32 v13, v13, v29
  v_add_f32 v125, v125, v45
  v_add_f32 v13, v13, v125
  v_add_f32 v14, v14, v30
  v_add_f32 v126, v126, v46
  v_add_f32 v14, v14, v126
  v_add_f32 v15, v15, v31
  v_add_f32 v127, v127, v47
  v_add_f32 v15, v15, v127
  v_cvt_pk_bf16_f32 v64, v0, v1
  v_cvt_pk_bf16_f32 v65, v2, v3
  v_cvt_pk_bf16_f32 v66, v4, v5
  v_cvt_pk_bf16_f32 v67, v6, v7
  v_cvt_pk_bf16_f32 v68, v8, v9
  v_cvt_pk_bf16_f32 v69, v10, v11
  v_cvt_pk_bf16_f32 v70, v12, v13
  v_cvt_pk_bf16_f32 v71, v14, v15
  buffer_store_dwordx4 v[64:67], v94, s[8:11], s55 offen
  buffer_store_dwordx4 v[68:71], v94, s[8:11], s55 offen offset:32
K_fin:
K_end:
  s_endpgm
K_rare1:
  v_max3_f32 v154, v112, v113, v114
  v_max3_f32 v155, v115, v116, v117
  v_max3_f32 v154, v154, v118, v119
  v_max3_f32 v155, v155, v120, v121
  v_max3_f32 v154, v154, v122, v123
  v_max3_f32 v155, v155, v124, v125
  v_max3_f32 v154, v154, v126, v127
  v_max_f32 v154, v154, v155
  v_mov_b32 v155, v154
  s_nop 1
  v_permlane32_swap_b32 v154, v155
  s_nop 1
  v_max_f32 v154, v154, v155
  v_max_f32 v154, 0, v154
  v_add_f32 v164, v164, v154
  v_sub_f32 v155, 0, v154
  v_exp_f32 v155, v155
  s_nop 0
  v_mul_f32 v165, v165, v155
  v_mul_f32 v0, v0, v155
  v_mul_f32 v1, v1, v155
  v_mul_f32 v2, v2, v155
  v_mul_f32 v3, v3, v155
  v_mul_f32 v4, v4, v155
  v_mul_f32 v5, v5, v155
  v_mul_f32 v6, v6, v155
  v_mul_f32 v7, v7, v155
  v_mul_f32 v8, v8, v155
  v_mul_f32 v9, v9, v155
  v_mul_f32 v10, v10, v155
  v_mul_f32 v11, v11, v155
  v_mul_f32 v12, v12, v155
  v_mul_f32 v13, v13, v155
  v_mul_f32 v14, v14, v155
  v_mul_f32 v15, v15, v155
  v_mul_f32 v16, v16, v155
  v_mul_f32 v17, v17, v155
  v_mul_f32 v18, v18, v155
  v_mul_f32 v19, v19, v155
  v_mul_f32 v20, v20, v155
  v_mul_f32 v21, v21, v155
  v_mul_f32 v22, v22, v155
  v_mul_f32 v23, v23, v155
  v_mul_f32 v24, v24, v155
  v_mul_f32 v25, v25, v155
  v_mul_f32 v26, v26, v155
  v_mul_f32 v27, v27, v155
  v_mul_f32 v28, v28, v155
  v_mul_f32 v29, v29, v155
  v_mul_f32 v30, v30, v155
  v_mul_f32 v31, v31, v155
  v_mul_f32 v32, v32, v155
  v_mul_f32 v33, v33, v155
  v_mul_f32 v34, v34, v155
  v_mul_f32 v35, v35, v155
  v_mul_f32 v36, v36, v155
  v_mul_f32 v37, v37, v155
  v_mul_f32 v38, v38, v155
  v_mul_f32 v39, v39, v155
  v_mul_f32 v40, v40, v155
  v_mul_f32 v41, v41, v155
  v_mul_f32 v42, v42, v155
  v_mul_f32 v43, v43, v155
  v_mul_f32 v44, v44, v155
  v_mul_f32 v45, v45, v155
  v_mul_f32 v46, v46, v155
  v_mul_f32 v47, v47, v155
  v_mul_f32 v48, v48, v155
  v_mul_f32 v49, v49, v155
  v_mul_f32 v50, v50, v155
  v_mul_f32 v51, v51, v155
  v_mul_f32 v52, v52, v155
  v_mul_f32 v53, v53, v155
  v_mul_f32 v54, v54, v155
  v_mul_f32 v55, v55, v155
  v_mul_f32 v56, v56, v155
  v_mul_f32 v57, v57, v155
  v_mul_f32 v58, v58, v155
  v_mul_f32 v59, v59, v155
  v_mul_f32 v60, v60, v155
  v_mul_f32 v61, v61, v155
  v_mul_f32 v62, v62, v155
  v_mul_f32 v63, v63, v155
  v_sub_f32 v112, v112, v154
  v_sub_f32 v113, v113, v154
  v_sub_f32 v114, v114, v154
  v_sub_f32 v115, v115, v154
  v_sub_f32 v116, v116, v154
  v_sub_f32 v117, v117, v154
  v_sub_f32 v118, v118, v154
  v_sub_f32 v119, v119, v154
  v_sub_f32 v120, v120, v154
  v_sub_f32 v121, v121, v154
  v_sub_f32 v122, v122, v154
  v_sub_f32 v123, v123, v154
  v_sub_f32 v124, v124, v154
  v_sub_f32 v125, v125, v154
  v_sub_f32 v126, v126, v154
  v_sub_f32 v127, v127, v154
  v_exp_f32 v152, v112
  v_exp_f32 v153, v113
  v_mov_b32 v158, v152
  v_cvt_pk_bf16_f32 v128, v152, v153
  v_mov_b32 v159, v153
  v_exp_f32 v154, v114
  v_exp_f32 v155, v115
  v_add_f32 v158, v158, v154
  v_cvt_pk_bf16_f32 v129, v154, v155
  v_add_f32 v159, v159, v155
  v_exp_f32 v156, v116
  v_exp_f32 v157, v117
  v_add_f32 v158, v158, v156
  v_cvt_pk_bf16_f32 v130, v156, v157
  v_add_f32 v159, v159, v157
  v_exp_f32 v152, v118
  v_exp_f32 v153, v119
  v_add_f32 v158, v158, v152
  v_cvt_pk_bf16_f32 v131, v152, v153
  v_add_f32 v159, v159, v153
  v_exp_f32 v154, v120
  v_exp_f32 v155, v121
  v_add_f32 v158, v158, v154
  v_cvt_pk_bf16_f32 v132, v154, v155
  v_add_f32 v159, v159, v155
  v_exp_f32 v156, v122
  v_exp_f32 v157, v123
  v_add_f32 v158, v158, v156
  v_cvt_pk_bf16_f32 v133, v156, v157
  v_add_f32 v159, v159, v157
  v_exp_f32 v152, v124
  v_exp_f32 v153, v125
  v_add_f32 v158, v158, v152
  v_cvt_pk_bf16_f32 v134, v152, v153
  v_add_f32 v159, v159, v153
  v_exp_f32 v154, v126
  v_exp_f32 v155, v127
  v_add_f32 v158, v158, v154
  v_cvt_pk_bf16_f32 v135, v154, v155
  v_add_f32 v159, v159, v155
  v_add_f32 v158, v158, v159
  s_branch K_back1
K_rare2:
  v_max3_f32 v154, v96, v97, v98
  v_max3_f32 v155, v99, v100, v101
  v_max3_f32 v154, v154, v102, v103
  v_max3_f32 v155, v155, v104, v105
  v_max3_f32 v154, v154, v106, v107
  v_max3_f32 v155, v155, v108, v109
  v_max3_f32 v154, v154, v110, v111
  v_max_f32 v154, v154, v155
  v_mov_b32 v155, v154
  s_nop 1
  v_permlane32_swap_b32 v154, v155
  s_nop 1
  v_max_f32 v154, v154, v155
  v_max_f32 v154, 0, v154
  v_add_f32 v164, v164, v154
  v_sub_f32 v155, 0, v154
  v_exp_f32 v155, v155
  s_nop 0
  v_mul_f32 v165, v165, v155
  v_mul_f32 v0, v0, v155
  v_mul_f32 v1, v1, v155
  v_mul_f32 v2, v2, v155
  v_mul_f32 v3, v3, v155
  v_mul_f32 v4, v4, v155
  v_mul_f32 v5, v5, v155
  v_mul_f32 v6, v6, v155
  v_mul_f32 v7, v7, v155
  v_mul_f32 v8, v8, v155
  v_mul_f32 v9, v9, v155
  v_mul_f32 v10, v10, v155
  v_mul_f32 v11, v11, v155
  v_mul_f32 v12, v12, v155
  v_mul_f32 v13, v13, v155
  v_mul_f32 v14, v14, v155
  v_mul_f32 v15, v15, v155
  v_mul_f32 v16, v16, v155
  v_mul_f32 v17, v17, v155
  v_mul_f32 v18, v18, v155
  v_mul_f32 v19, v19, v155
  v_mul_f32 v20, v20, v155
  v_mul_f32 v21, v21, v155
  v_mul_f32 v22, v22, v155
  v_mul_f32 v23, v23, v155
  v_mul_f32 v24, v24, v155
  v_mul_f32 v25, v25, v155
  v_mul_f32 v26, v26, v155
  v_mul_f32 v27, v27, v155
  v_mul_f32 v28, v28, v155
  v_mul_f32 v29, v29, v155
  v_mul_f32 v30, v30, v155
  v_mul_f32 v31, v31, v155
  v_mul_f32 v32, v32, v155
  v_mul_f32 v33, v33, v155
  v_mul_f32 v34, v34, v155
  v_mul_f32 v35, v35, v155
  v_mul_f32 v36, v36, v155
  v_mul_f32 v37, v37, v155
  v_mul_f32 v38, v38, v155
  v_mul_f32 v39, v39, v155
  v_mul_f32 v40, v40, v155
  v_mul_f32 v41, v41, v155
  v_mul_f32 v42, v42, v155
  v_mul_f32 v43, v43, v155
  v_mul_f32 v44, v44, v155
  v_mul_f32 v45, v45, v155
  v_mul_f32 v46, v46, v155
  v_mul_f32 v47, v47, v155
  v_mul_f32 v48, v48, v155
  v_mul_f32 v49, v49, v155
  v_mul_f32 v50, v50, v155
  v_mul_f32 v51, v51, v155
  v_mul_f32 v52, v52, v155
  v_mul_f32 v53, v53, v155
  v_mul_f32 v54, v54, v155
  v_mul_f32 v55, v55, v155
  v_mul_f32 v56, v56, v155
  v_mul_f32 v57, v57, v155
  v_mul_f32 v58, v58, v155
  v_mul_f32 v59, v59, v155
  v_mul_f32 v60, v60, v155
  v_mul_f32 v61, v61, v155
  v_mul_f32 v62, v62, v155
  v_mul_f32 v63, v63, v155
  v_sub_f32 v96, v96, v154
  v_sub_f32 v97, v97, v154
  v_sub_f32 v98, v98, v154
  v_sub_f32 v99, v99, v154
  v_sub_f32 v100, v100, v154
  v_sub_f32 v101, v101, v154
  v_sub_f32 v102, v102, v154
  v_sub_f32 v103, v103, v154
  v_sub_f32 v104, v104, v154
  v_sub_f32 v105, v105, v154
  v_sub_f32 v106, v106, v154
  v_sub_f32 v107, v107, v154
  v_sub_f32 v108, v108, v154
  v_sub_f32 v109, v109, v154
  v_sub_f32 v110, v110, v154
  v_sub_f32 v111, v111, v154
  v_exp_f32 v152, v96
  v_exp_f32 v153, v97
  v_mov_b32 v158, v152
  v_cvt_pk_bf16_f32 v128, v152, v153
  v_mov_b32 v159, v153
  v_exp_f32 v154, v98
  v_exp_f32 v155, v99
  v_add_f32 v158, v158, v154
  v_cvt_pk_bf16_f32 v129, v154, v155
  v_add_f32 v159, v159, v155
  v_exp_f32 v156, v100
  v_exp_f32 v157, v101
  v_add_f32 v158, v158, v156
  v_cvt_pk_bf16_f32 v130, v156, v157
  v_add_f32 v159, v159, v157
  v_exp_f32 v152, v102
  v_exp_f32 v153, v103
  v_add_f32 v158, v158, v152
  v_cvt_pk_bf16_f32 v131, v152, v153
  v_add_f32 v159, v159, v153
  v_exp_f32 v154, v104
  v_exp_f32 v155, v105
  v_add_f32 v158, v158, v154
  v_cvt_pk_bf16_f32 v132, v154, v155
  v_add_f32 v159, v159, v155
  v_exp_f32 v156, v106
  v_exp_f32 v157, v107
  v_add_f32 v158, v158, v156
  v_cvt_pk_bf16_f32 v133, v156, v157
  v_add_f32 v159, v159, v157
  v_exp_f32 v152, v108
  v_exp_f32 v153, v109
  v_add_f32 v158, v158, v152
  v_cvt_pk_bf16_f32 v134, v152, v153
  v_add_f32 v159, v159, v153
  v_exp_f32 v154, v110
  v_exp_f32 v155, v111
  v_add_f32 v158, v158, v154
  v_cvt_pk_bf16_f32 v135, v154, v155
  v_add_f32 v159, v159, v155
  v_add_f32 v158, v158, v159
  s_branch K_back2
K_rare3:
  v_max3_f32 v154, v112, v113, v114
  v_max3_f32 v155, v115, v116, v117
  v_max3_f32 v154, v154, v118, v119
  v_max3_f32 v155, v155, v120, v121
  v_max3_f32 v154, v154, v122, v123
  v_max3_f32 v155, v155, v124, v125
  v_max3_f32 v154, v154, v126, v127
  v_max_f32 v154, v154, v155
  v_mov_b32 v155, v154
  s_nop 1
  v_permlane32_swap_b32 v154, v155
  s_nop 1
  v_max_f32 v154, v154, v155
  v_max_f32 v154, 0, v154
  v_add_f32 v164, v164, v154
  v_sub_f32 v155, 0, v154
  v_exp_f32 v155, v155
  s_nop 0
  v_mul_f32 v165, v165, v155
  v_mul_f32 v0, v0, v155
  v_mul_f32 v1, v1, v155
  v_mul_f32 v2, v2, v155
  v_mul_f32 v3, v3, v155
  v_mul_f32 v4, v4, v155
  v_mul_f32 v5, v5, v155
  v_mul_f32 v6, v6, v155
  v_mul_f32 v7, v7, v155
  v_mul_f32 v8, v8, v155
  v_mul_f32 v9, v9, v155
  v_mul_f32 v10, v10, v155
  v_mul_f32 v11, v11, v155
  v_mul_f32 v12, v12, v155
  v_mul_f32 v13, v13, v155
  v_mul_f32 v14, v14, v155
  v_mul_f32 v15, v15, v155
  v_mul_f32 v16, v16, v155
  v_mul_f32 v17, v17, v155
  v_mul_f32 v18, v18, v155
  v_mul_f32 v19, v19, v155
  v_mul_f32 v20, v20, v155
  v_mul_f32 v21, v21, v155
  v_mul_f32 v22, v22, v155
  v_mul_f32 v23, v23, v155
  v_mul_f32 v24, v24, v155
  v_mul_f32 v25, v25, v155
  v_mul_f32 v26, v26, v155
  v_mul_f32 v27, v27, v155
  v_mul_f32 v28, v28, v155
  v_mul_f32 v29, v29, v155
  v_mul_f32 v30, v30, v155
  v_mul_f32 v31, v31, v155
  v_mul_f32 v32, v32, v155
  v_mul_f32 v33, v33, v155
  v_mul_f32 v34, v34, v155
  v_mul_f32 v35, v35, v155
  v_mul_f32 v36, v36, v155
  v_mul_f32 v37, v37, v155
  v_mul_f32 v38, v38, v155
  v_mul_f32 v39, v39, v155
  v_mul_f32 v40, v40, v155
  v_mul_f32 v41, v41, v155
  v_mul_f32 v42, v42, v155
  v_mul_f32 v43, v43, v155
  v_mul_f32 v44, v44, v155
  v_mul_f32 v45, v45, v155
  v_mul_f32 v46, v46, v155
  v_mul_f32 v47, v47, v155
  v_mul_f32 v48, v48, v155
  v_mul_f32 v49, v49, v155
  v_mul_f32 v50, v50, v155
  v_mul_f32 v51, v51, v155
  v_mul_f32 v52, v52, v155
  v_mul_f32 v53, v53, v155
  v_mul_f32 v54, v54, v155
  v_mul_f32 v55, v55, v155
  v_mul_f32 v56, v56, v155
  v_mul_f32 v57, v57, v155
  v_mul_f32 v58, v58, v155
  v_mul_f32 v59, v59, v155
  v_mul_f32 v60, v60, v155
  v_mul_f32 v61, v61, v155
  v_mul_f32 v62, v62, v155
  v_mul_f32 v63, v63, v155
  v_sub_f32 v112, v112, v154
  v_sub_f32 v113, v113, v154
  v_sub_f32 v114, v114, v154
  v_sub_f32 v115, v115, v154
  v_sub_f32 v116, v116, v154
  v_sub_f32 v117, v117, v154
  v_sub_f32 v118, v118, v154
  v_sub_f32 v119, v119, v154
  v_sub_f32 v120, v120, v154
  v_sub_f32 v121, v121, v154
  v_sub_f32 v122, v122, v154
  v_sub_f32 v123, v123, v154
  v_sub_f32 v124, v124, v154
  v_sub_f32 v125, v125, v154
  v_sub_f32 v126, v126, v154
  v_sub_f32 v127, v127, v154
  v_exp_f32 v152, v112
  v_exp_f32 v153, v113
  v_mov_b32 v158, v152
  v_cvt_pk_bf16_f32 v128, v152, v153
  v_mov_b32 v159, v153
  v_exp_f32 v154, v114
  v_exp_f32 v155, v115
  v_add_f32 v158, v158, v154
  v_cvt_pk_bf16_f32 v129, v154, v155
  v_add_f32 v159, v159, v155
  v_exp_f32 v156, v116
  v_exp_f32 v157, v117
  v_add_f32 v158, v158, v156
  v_cvt_pk_bf16_f32 v130, v156, v157
  v_add_f32 v159, v159, v157
  v_exp_f32 v152, v118
  v_exp_f32 v153, v119
  v_add_f32 v158, v158, v152
  v_cvt_pk_bf16_f32 v131, v152, v153
  v_add_f32 v159, v159, v153
  v_exp_f32 v154, v120
  v_exp_f32 v155, v121
  v_add_f32 v158, v158, v154
  v_cvt_pk_bf16_f32 v132, v154, v155
  v_add_f32 v159, v159, v155
  v_exp_f32 v156, v122
  v_exp_f32 v157, v123
  v_add_f32 v158, v158, v156
  v_cvt_pk_bf16_f32 v133, v156, v157
  v_add_f32 v159, v159, v157
  v_exp_f32 v152, v124
  v_exp_f32 v153, v125
  v_add_f32 v158, v158, v152
  v_cvt_pk_bf16_f32 v134, v152, v153
  v_add_f32 v159, v159, v153
  v_exp_f32 v154, v126
  v_exp_f32 v155, v127
  v_add_f32 v158, v158, v154
  v_cvt_pk_bf16_f32 v135, v154, v155
  v_add_f32 v159, v159, v155
  v_add_f32 v158, v158, v159
  s_branch K_back3
K_rare4:
  v_max3_f32 v154, v96, v97, v98
  v_max3_f32 v155, v99, v100, v101
  v_max3_f32 v154, v154, v102, v103
  v_max3_f32 v155, v155, v104, v105
  v_max3_f32 v154, v154, v106, v107
  v_max3_f32 v155, v155, v108, v109
  v_max3_f32 v154, v154, v110, v111
  v_max_f32 v154, v154, v155
  v_mov_b32 v155, v154
  s_nop 1
  v_permlane32_swap_b32 v154, v155
  s_nop 1
  v_max_f32 v154, v154, v155
  v_max_f32 v154, 0, v154
  v_add_f32 v164, v164, v154
  v_sub_f32 v155, 0, v154
  v_exp_f32 v155, v155
  s_nop 0
  v_mul_f32 v165, v165, v155
  v_mul_f32 v0, v0, v155
  v_mul_f32 v1, v1, v155
  v_mul_f32 v2, v2, v155
  v_mul_f32 v3, v3, v155
  v_mul_f32 v4, v4, v155
  v_mul_f32 v5, v5, v155
  v_mul_f32 v6, v6, v155
  v_mul_f32 v7, v7, v155
  v_mul_f32 v8, v8, v155
  v_mul_f32 v9, v9, v155
  v_mul_f32 v10, v10, v155
  v_mul_f32 v11, v11, v155
  v_mul_f32 v12, v12, v155
  v_mul_f32 v13, v13, v155
  v_mul_f32 v14, v14, v155
  v_mul_f32 v15, v15, v155
  v_mul_f32 v16, v16, v155
  v_mul_f32 v17, v17, v155
  v_mul_f32 v18, v18, v155
  v_mul_f32 v19, v19, v155
  v_mul_f32 v20, v20, v155
  v_mul_f32 v21, v21, v155
  v_mul_f32 v22, v22, v155
  v_mul_f32 v23, v23, v155
  v_mul_f32 v24, v24, v155
  v_mul_f32 v25, v25, v155
  v_mul_f32 v26, v26, v155
  v_mul_f32 v27, v27, v155
  v_mul_f32 v28, v28, v155
  v_mul_f32 v29, v29, v155
  v_mul_f32 v30, v30, v155
  v_mul_f32 v31, v31, v155
  v_mul_f32 v32, v32, v155
  v_mul_f32 v33, v33, v155
  v_mul_f32 v34, v34, v155
  v_mul_f32 v35, v35, v155
  v_mul_f32 v36, v36, v155
  v_mul_f32 v37, v37, v155
  v_mul_f32 v38, v38, v155
  v_mul_f32 v39, v39, v155
  v_mul_f32 v40, v40, v155
  v_mul_f32 v41, v41, v155
  v_mul_f32 v42, v42, v155
  v_mul_f32 v43, v43, v155
  v_mul_f32 v44, v44, v155
  v_mul_f32 v45, v45, v155
  v_mul_f32 v46, v46, v155
  v_mul_f32 v47, v47, v155
  v_mul_f32 v48, v48, v155
  v_mul_f32 v49, v49, v155
  v_mul_f32 v50, v50, v155
  v_mul_f32 v51, v51, v155
  v_mul_f32 v52, v52, v155
  v_mul_f32 v53, v53, v155
  v_mul_f32 v54, v54, v155
  v_mul_f32 v55, v55, v155
  v_mul_f32 v56, v56, v155
  v_mul_f32 v57, v57, v155
  v_mul_f32 v58, v58, v155
  v_mul_f32 v59, v59, v155
  v_mul_f32 v60, v60, v155
  v_mul_f32 v61, v61, v155
  v_mul_f32 v62, v62, v155
  v_mul_f32 v63, v63, v155
  v_sub_f32 v96, v96, v154
  v_sub_f32 v97, v97, v154
  v_sub_f32 v98, v98, v154
  v_sub_f32 v99, v99, v154
  v_sub_f32 v100, v100, v154
  v_sub_f32 v101, v101, v154
  v_sub_f32 v102, v102, v154
  v_sub_f32 v103, v103, v154
  v_sub_f32 v104, v104, v154
  v_sub_f32 v105, v105, v154
  v_sub_f32 v106, v106, v154
  v_sub_f32 v107, v107, v154
  v_sub_f32 v108, v108, v154
  v_sub_f32 v109, v109, v154
  v_sub_f32 v110, v110, v154
  v_sub_f32 v111, v111, v154
  v_exp_f32 v152, v96
  v_exp_f32 v153, v97
  v_mov_b32 v158, v152
  v_cvt_pk_bf16_f32 v128, v152, v153
  v_mov_b32 v159, v153
  v_exp_f32 v154, v98
  v_exp_f32 v155, v99
  v_add_f32 v158, v158, v154
  v_cvt_pk_bf16_f32 v129, v154, v155
  v_add_f32 v159, v159, v155
  v_exp_f32 v156, v100
  v_exp_f32 v157, v101
  v_add_f32 v158, v158, v156
  v_cvt_pk_bf16_f32 v130, v156, v157
  v_add_f32 v159, v159, v157
  v_exp_f32 v152, v102
  v_exp_f32 v153, v103
  v_add_f32 v158, v158, v152
  v_cvt_pk_bf16_f32 v131, v152, v153
  v_add_f32 v159, v159, v153
  v_exp_f32 v154, v104
  v_exp_f32 v155, v105
  v_add_f32 v158, v158, v154
  v_cvt_pk_bf16_f32 v132, v154, v155
  v_add_f32 v159, v159, v155
  v_exp_f32 v156, v106
  v_exp_f32 v157, v107
  v_add_f32 v158, v158, v156
  v_cvt_pk_bf16_f32 v133, v156, v157
  v_add_f32 v159, v159, v157
  v_exp_f32 v152, v108
  v_exp_f32 v153, v109
  v_add_f32 v158, v158, v152
  v_cvt_pk_bf16_f32 v134, v152, v153
  v_add_f32 v159, v159, v153
  v_exp_f32 v154, v110
  v_exp_f32 v155, v111
  v_add_f32 v158, v158, v154
  v_cvt_pk_bf16_f32 v135, v154, v155
  v_add_f32 v159, v159, v155
  v_add_f32 v158, v158, v159
  s_branch K_back4
K_rare5:
  v_max3_f32 v154, v112, v113, v114
  v_max3_f32 v155, v115, v116, v117
  v_max3_f32 v154, v154, v118, v119
  v_max3_f32 v155, v155, v120, v121
  v_max3_f32 v154, v154, v122, v123
  v_max3_f32 v155, v155, v124, v125
  v_max3_f32 v154, v154, v126, v127
  v_max_f32 v154, v154, v155
  v_mov_b32 v155, v154
  s_nop 1
  v_permlane32_swap_b32 v154, v155
  s_nop 1
  v_max_f32 v154, v154, v155
  v_max_f32 v154, 0, v154
  v_add_f32 v164, v164, v154
  v_sub_f32 v155, 0, v154
  v_exp_f32 v155, v155
  s_nop 0
  v_mul_f32 v165, v165, v155
  v_mul_f32 v0, v0, v155
  v_mul_f32 v1, v1, v155
  v_mul_f32 v2, v2, v155
  v_mul_f32 v3, v3, v155
  v_mul_f32 v4, v4, v155
  v_mul_f32 v5, v5, v155
  v_mul_f32 v6, v6, v155
  v_mul_f32 v7, v7, v155
  v_mul_f32 v8, v8, v155
  v_mul_f32 v9, v9, v155
  v_mul_f32 v10, v10, v155
  v_mul_f32 v11, v11, v155
  v_mul_f32 v12, v12, v155
  v_mul_f32 v13, v13, v155
  v_mul_f32 v14, v14, v155
  v_mul_f32 v15, v15, v155
  v_mul_f32 v16, v16, v155
  v_mul_f32 v17, v17, v155
  v_mul_f32 v18, v18, v155
  v_mul_f32 v19, v19, v155
  v_mul_f32 v20, v20, v155
  v_mul_f32 v21, v21, v155
  v_mul_f32 v22, v22, v155
  v_mul_f32 v23, v23, v155
  v_mul_f32 v24, v24, v155
  v_mul_f32 v25, v25, v155
  v_mul_f32 v26, v26, v155
  v_mul_f32 v27, v27, v155
  v_mul_f32 v28, v28, v155
  v_mul_f32 v29, v29, v155
  v_mul_f32 v30, v30, v155
  v_mul_f32 v31, v31, v155
  v_mul_f32 v32, v32, v155
  v_mul_f32 v33, v33, v155
  v_mul_f32 v34, v34, v155
  v_mul_f32 v35, v35, v155
  v_mul_f32 v36, v36, v155
  v_mul_f32 v37, v37, v155
  v_mul_f32 v38, v38, v155
  v_mul_f32 v39, v39, v155
  v_mul_f32 v40, v40, v155
  v_mul_f32 v41, v41, v155
  v_mul_f32 v42, v42, v155
  v_mul_f32 v43, v43, v155
  v_mul_f32 v44, v44, v155
  v_mul_f32 v45, v45, v155
  v_mul_f32 v46, v46, v155
  v_mul_f32 v47, v47, v155
  v_mul_f32 v48, v48, v155
  v_mul_f32 v49, v49, v155
  v_mul_f32 v50, v50, v155
  v_mul_f32 v51, v51, v155
  v_mul_f32 v52, v52, v155
  v_mul_f32 v53, v53, v155
  v_mul_f32 v54, v54, v155
  v_mul_f32 v55, v55, v155
  v_mul_f32 v56, v56, v155
  v_mul_f32 v57, v57, v155
  v_mul_f32 v58, v58, v155
  v_mul_f32 v59, v59, v155
  v_mul_f32 v60, v60, v155
  v_mul_f32 v61, v61, v155
  v_mul_f32 v62, v62, v155
  v_mul_f32 v63, v63, v155
  v_sub_f32 v112, v112, v154
  v_sub_f32 v113, v113, v154
  v_sub_f32 v114, v114, v154
  v_sub_f32 v115, v115, v154
  v_sub_f32 v116, v116, v154
  v_sub_f32 v117, v117, v154
  v_sub_f32 v118, v118, v154
  v_sub_f32 v119, v119, v154
  v_sub_f32 v120, v120, v154
  v_sub_f32 v121, v121, v154
  v_sub_f32 v122, v122, v154
  v_sub_f32 v123, v123, v154
  v_sub_f32 v124, v124, v154
  v_sub_f32 v125, v125, v154
  v_sub_f32 v126, v126, v154
  v_sub_f32 v127, v127, v154
  v_exp_f32 v152, v112
  v_exp_f32 v153, v113
  v_mov_b32 v158, v152
  v_cvt_pk_bf16_f32 v128, v152, v153
  v_mov_b32 v159, v153
  v_exp_f32 v154, v114
  v_exp_f32 v155, v115
  v_add_f32 v158, v158, v154
  v_cvt_pk_bf16_f32 v129, v154, v155
  v_add_f32 v159, v159, v155
  v_exp_f32 v156, v116
  v_exp_f32 v157, v117
  v_add_f32 v158, v158, v156
  v_cvt_pk_bf16_f32 v130, v156, v157
  v_add_f32 v159, v159, v157
  v_exp_f32 v152, v118
  v_exp_f32 v153, v119
  v_add_f32 v158, v158, v152
  v_cvt_pk_bf16_f32 v131, v152, v153
  v_add_f32 v159, v159, v153
  v_exp_f32 v154, v120
  v_exp_f32 v155, v121
  v_add_f32 v158, v158, v154
  v_cvt_pk_bf16_f32 v132, v154, v155
  v_add_f32 v159, v159, v155
  v_exp_f32 v156, v122
  v_exp_f32 v157, v123
  v_add_f32 v158, v158, v156
  v_cvt_pk_bf16_f32 v133, v156, v157
  v_add_f32 v159, v159, v157
  v_exp_f32 v152, v124
  v_exp_f32 v153, v125
  v_add_f32 v158, v158, v152
  v_cvt_pk_bf16_f32 v134, v152, v153
  v_add_f32 v159, v159, v153
  v_exp_f32 v154, v126
  v_exp_f32 v155, v127
  v_add_f32 v158, v158, v154
  v_cvt_pk_bf16_f32 v135, v154, v155
  v_add_f32 v159, v159, v155
  v_add_f32 v158, v158, v159
  s_branch K_back5
K_rare6:
  v_max3_f32 v154, v96, v97, v98
  v_max3_f32 v155, v99, v100, v101
  v_max3_f32 v154, v154, v102, v103
  v_max3_f32 v155, v155, v104, v105
  v_max3_f32 v154, v154, v106, v107
  v_max3_f32 v155, v155, v108, v109
  v_max3_f32 v154, v154, v110, v111
  v_max_f32 v154, v154, v155
  v_mov_b32 v155, v154
  s_nop 1
  v_permlane32_swap_b32 v154, v155
  s_nop 1
  v_max_f32 v154, v154, v155
  v_max_f32 v154, 0, v154
  v_add_f32 v164, v164, v154
  v_sub_f32 v155, 0, v154
  v_exp_f32 v155, v155
  s_nop 0
  v_mul_f32 v165, v165, v155
  v_mul_f32 v0, v0, v155
  v_mul_f32 v1, v1, v155
  v_mul_f32 v2, v2, v155
  v_mul_f32 v3, v3, v155
  v_mul_f32 v4, v4, v155
  v_mul_f32 v5, v5, v155
  v_mul_f32 v6, v6, v155
  v_mul_f32 v7, v7, v155
  v_mul_f32 v8, v8, v155
  v_mul_f32 v9, v9, v155
  v_mul_f32 v10, v10, v155
  v_mul_f32 v11, v11, v155
  v_mul_f32 v12, v12, v155
  v_mul_f32 v13, v13, v155
  v_mul_f32 v14, v14, v155
  v_mul_f32 v15, v15, v155
  v_mul_f32 v16, v16, v155
  v_mul_f32 v17, v17, v155
  v_mul_f32 v18, v18, v155
  v_mul_f32 v19, v19, v155
  v_mul_f32 v20, v20, v155
  v_mul_f32 v21, v21, v155
  v_mul_f32 v22, v22, v155
  v_mul_f32 v23, v23, v155
  v_mul_f32 v24, v24, v155
  v_mul_f32 v25, v25, v155
  v_mul_f32 v26, v26, v155
  v_mul_f32 v27, v27, v155
  v_mul_f32 v28, v28, v155
  v_mul_f32 v29, v29, v155
  v_mul_f32 v30, v30, v155
  v_mul_f32 v31, v31, v155
  v_mul_f32 v32, v32, v155
  v_mul_f32 v33, v33, v155
  v_mul_f32 v34, v34, v155
  v_mul_f32 v35, v35, v155
  v_mul_f32 v36, v36, v155
  v_mul_f32 v37, v37, v155
  v_mul_f32 v38, v38, v155
  v_mul_f32 v39, v39, v155
  v_mul_f32 v40, v40, v155
  v_mul_f32 v41, v41, v155
  v_mul_f32 v42, v42, v155
  v_mul_f32 v43, v43, v155
  v_mul_f32 v44, v44, v155
  v_mul_f32 v45, v45, v155
  v_mul_f32 v46, v46, v155
  v_mul_f32 v47, v47, v155
  v_mul_f32 v48, v48, v155
  v_mul_f32 v49, v49, v155
  v_mul_f32 v50, v50, v155
  v_mul_f32 v51, v51, v155
  v_mul_f32 v52, v52, v155
  v_mul_f32 v53, v53, v155
  v_mul_f32 v54, v54, v155
  v_mul_f32 v55, v55, v155
  v_mul_f32 v56, v56, v155
  v_mul_f32 v57, v57, v155
  v_mul_f32 v58, v58, v155
  v_mul_f32 v59, v59, v155
  v_mul_f32 v60, v60, v155
  v_mul_f32 v61, v61, v155
  v_mul_f32 v62, v62, v155
  v_mul_f32 v63, v63, v155
  v_sub_f32 v96, v96, v154
  v_sub_f32 v97, v97, v154
  v_sub_f32 v98, v98, v154
  v_sub_f32 v99, v99, v154
  v_sub_f32 v100, v100, v154
  v_sub_f32 v101, v101, v154
  v_sub_f32 v102, v102, v154
  v_sub_f32 v103, v103, v154
  v_sub_f32 v104, v104, v154
  v_sub_f32 v105, v105, v154
  v_sub_f32 v106, v106, v154
  v_sub_f32 v107, v107, v154
  v_sub_f32 v108, v108, v154
  v_sub_f32 v109, v109, v154
  v_sub_f32 v110, v110, v154
  v_sub_f32 v111, v111, v154
  v_exp_f32 v152, v96
  v_exp_f32 v153, v97
  v_mov_b32 v158, v152
  v_cvt_pk_bf16_f32 v128, v152, v153
  v_mov_b32 v159, v153
  v_exp_f32 v154, v98
  v_exp_f32 v155, v99
  v_add_f32 v158, v158, v154
  v_cvt_pk_bf16_f32 v129, v154, v155
  v_add_f32 v159, v159, v155
  v_exp_f32 v156, v100
  v_exp_f32 v157, v101
  v_add_f32 v158, v158, v156
  v_cvt_pk_bf16_f32 v130, v156, v157
  v_add_f32 v159, v159, v157
  v_exp_f32 v152, v102
  v_exp_f32 v153, v103
  v_add_f32 v158, v158, v152
  v_cvt_pk_bf16_f32 v131, v152, v153
  v_add_f32 v159, v159, v153
  v_exp_f32 v154, v104
  v_exp_f32 v155, v105
  v_add_f32 v158, v158, v154
  v_cvt_pk_bf16_f32 v132, v154, v155
  v_add_f32 v159, v159, v155
  v_exp_f32 v156, v106
  v_exp_f32 v157, v107
  v_add_f32 v158, v158, v156
  v_cvt_pk_bf16_f32 v133, v156, v157
  v_add_f32 v159, v159, v157
  v_exp_f32 v152, v108
  v_exp_f32 v153, v109
  v_add_f32 v158, v158, v152
  v_cvt_pk_bf16_f32 v134, v152, v153
  v_add_f32 v159, v159, v153
  v_exp_f32 v154, v110
  v_exp_f32 v155, v111
  v_add_f32 v158, v158, v154
  v_cvt_pk_bf16_f32 v135, v154, v155
  v_add_f32 v159, v159, v155
  v_add_f32 v158, v158, v159
  s_branch K_back6
K_rare7:
  v_max3_f32 v154, v112, v113, v114
  v_max3_f32 v155, v115, v116, v117
  v_max3_f32 v154, v154, v118, v119
  v_max3_f32 v155, v155, v120, v121
  v_max3_f32 v154, v154, v122, v123
  v_max3_f32 v155, v155, v124, v125
  v_max3_f32 v154, v154, v126, v127
  v_max_f32 v154, v154, v155
  v_mov_b32 v155, v154
  s_nop 1
  v_permlane32_swap_b32 v154, v155
  s_nop 1
  v_max_f32 v154, v154, v155
  v_max_f32 v154, 0, v154
  v_add_f32 v164, v164, v154
  v_sub_f32 v155, 0, v154
  v_exp_f32 v155, v155
  s_nop 0
  v_mul_f32 v165, v165, v155
  v_mul_f32 v0, v0, v155
  v_mul_f32 v1, v1, v155
  v_mul_f32 v2, v2, v155
  v_mul_f32 v3, v3, v155
  v_mul_f32 v4, v4, v155
  v_mul_f32 v5, v5, v155
  v_mul_f32 v6, v6, v155
  v_mul_f32 v7, v7, v155
  v_mul_f32 v8, v8, v155
  v_mul_f32 v9, v9, v155
  v_mul_f32 v10, v10, v155
  v_mul_f32 v11, v11, v155
  v_mul_f32 v12, v12, v155
  v_mul_f32 v13, v13, v155
  v_mul_f32 v14, v14, v155
  v_mul_f32 v15, v15, v155
  v_mul_f32 v16, v16, v155
  v_mul_f32 v17, v17, v155
  v_mul_f32 v18, v18, v155
  v_mul_f32 v19, v19, v155
  v_mul_f32 v20, v20, v155
  v_mul_f32 v21, v21, v155
  v_mul_f32 v22, v22, v155
  v_mul_f32 v23, v23, v155
  v_mul_f32 v24, v24, v155
  v_mul_f32 v25, v25, v155
  v_mul_f32 v26, v26, v155
  v_mul_f32 v27, v27, v155
  v_mul_f32 v28, v28, v155
  v_mul_f32 v29, v29, v155
  v_mul_f32 v30, v30, v155
  v_mul_f32 v31, v31, v155
  v_mul_f32 v32, v32, v155
  v_mul_f32 v33, v33, v155
  v_mul_f32 v34, v34, v155
  v_mul_f32 v35, v35, v155
  v_mul_f32 v36, v36, v155
  v_mul_f32 v37, v37, v155
  v_mul_f32 v38, v38, v155
  v_mul_f32 v39, v39, v155
  v_mul_f32 v40, v40, v155
  v_mul_f32 v41, v41, v155
  v_mul_f32 v42, v42, v155
  v_mul_f32 v43, v43, v155
  v_mul_f32 v44, v44, v155
  v_mul_f32 v45, v45, v155
  v_mul_f32 v46, v46, v155
  v_mul_f32 v47, v47, v155
  v_mul_f32 v48, v48, v155
  v_mul_f32 v49, v49, v155
  v_mul_f32 v50, v50, v155
  v_mul_f32 v51, v51, v155
  v_mul_f32 v52, v52, v155
  v_mul_f32 v53, v53, v155
  v_mul_f32 v54, v54, v155
  v_mul_f32 v55, v55, v155
  v_mul_f32 v56, v56, v155
  v_mul_f32 v57, v57, v155
  v_mul_f32 v58, v58, v155
  v_mul_f32 v59, v59, v155
  v_mul_f32 v60, v60, v155
  v_mul_f32 v61, v61, v155
  v_mul_f32 v62, v62, v155
  v_mul_f32 v63, v63, v155
  v_sub_f32 v112, v112, v154
  v_sub_f32 v113, v113, v154
  v_sub_f32 v114, v114, v154
  v_sub_f32 v115, v115, v154
  v_sub_f32 v116, v116, v154
  v_sub_f32 v117, v117, v154
  v_sub_f32 v118, v118, v154
  v_sub_f32 v119, v119, v154
  v_sub_f32 v120, v120, v154
  v_sub_f32 v121, v121, v154
  v_sub_f32 v122, v122, v154
  v_sub_f32 v123, v123, v154
  v_sub_f32 v124, v124, v154
  v_sub_f32 v125, v125, v154
  v_sub_f32 v126, v126, v154
  v_sub_f32 v127, v127, v154
  v_exp_f32 v152, v112
  v_exp_f32 v153, v113
  v_mov_b32 v158, v152
  v_cvt_pk_bf16_f32 v128, v152, v153
  v_mov_b32 v159, v153
  v_exp_f32 v154, v114
  v_exp_f32 v155, v115
  v_add_f32 v158, v158, v154
  v_cvt_pk_bf16_f32 v129, v154, v155
  v_add_f32 v159, v159, v155
  v_exp_f32 v156, v116
  v_exp_f32 v157, v117
  v_add_f32 v158, v158, v156
  v_cvt_pk_bf16_f32 v130, v156, v157
  v_add_f32 v159, v159, v157
  v_exp_f32 v152, v118
  v_exp_f32 v153, v119
  v_add_f32 v158, v158, v152
  v_cvt_pk_bf16_f32 v131, v152, v153
  v_add_f32 v159, v159, v153
  v_exp_f32 v154, v120
  v_exp_f32 v155, v121
  v_add_f32 v158, v158, v154
  v_cvt_pk_bf16_f32 v132, v154, v155
  v_add_f32 v159, v159, v155
  v_exp_f32 v156, v122
  v_exp_f32 v157, v123
  v_add_f32 v158, v158, v156
  v_cvt_pk_bf16_f32 v133, v156, v157
  v_add_f32 v159, v159, v157
  v_exp_f32 v152, v124
  v_exp_f32 v153, v125
  v_add_f32 v158, v158, v152
  v_cvt_pk_bf16_f32 v134, v152, v153
  v_add_f32 v159, v159, v153
  v_exp_f32 v154, v126
  v_exp_f32 v155, v127
  v_add_f32 v158, v158, v154
  v_cvt_pk_bf16_f32 v135, v154, v155
  v_add_f32 v159, v159, v155
  v_add_f32 v158, v158, v159
  s_branch K_back7
K_codeend:
  s_endpgm
.section .rodata,"a"
.p2align 6
.amdhsa_kernel standalone__mha_block_cached__near_ridge_kernel
  .amdhsa_next_free_vgpr 168
  .amdhsa_next_free_sgpr 102
  .amdhsa_accum_offset 168
  .amdhsa_group_segment_fixed_size 0
  .amdhsa_kernarg_size 64
  .amdhsa_user_sgpr_count 2
  .amdhsa_user_sgpr_kernarg_segment_ptr 1
  .amdhsa_system_sgpr_workgroup_id_x 1
.end_amdhsa_kernel
```
